```python
import torch

def _softmax(x, axis=-1):
    return torch.softmax(x, dim=axis)

def _gelu(x):
    return torch.nn.functional.gelu(x, approximate='tanh')

def _silu(x):
    return torch.nn.functional.silu(x)

def _sigmoid(x):
    return torch.sigmoid(x)

def _layernorm(x, axis=-1, eps=1e-05):
    m = x.mean(dim=axis, keepdim=True)
    v = x.var(dim=axis, keepdim=True, unbiased=False)
    return (x - m) / torch.sqrt(v + eps)

def _scatter_add(tgt, idx, src, axis=0):
    return tgt.clone().index_add_(axis, idx, src)

def _segment_sum(src, seg, n):
    out = torch.zeros((n,) + src.shape[1:], dtype=src.dtype)
    return out.index_add_(0, seg, src)

def _pad(x, pw):
    flat = tuple((v for pair in reversed(pw) for v in pair))
    return torch.nn.functional.pad(x, flat)
kernel_name = 'adaLN_cond__sliding_block__dense_activation_relu__prompt'

def setup_inputs():

    _w = lambda a: (lambda t: t.to(torch.bfloat16) if t.is_floating_point() else t)(torch.as_tensor(a))

    def _A_setup():
        B, S, D = (1, 2048, 448)
        return {'x': _w((lambda *s: torch.randn(*s, dtype=torch.bfloat16) * 0.05)(B, S, D)), 'wqkv': _w((lambda *s: torch.randn(*s, dtype=torch.bfloat16) * 0.05)(D, 3 * D)), 'wo': _w((lambda *s: torch.randn(*s, dtype=torch.bfloat16) * 0.05)(D, D))}
    _A_in = _A_setup()

    def _B_setup():
        B, S, D, Dff = (1, 2048, 448, 1792)
        return {'x': _w((lambda *s: torch.randn(*s, dtype=torch.bfloat16) * 0.05)(B, S, D)), 'w1': _w((lambda *s: torch.randn(*s, dtype=torch.bfloat16) * 0.05)(D, Dff)), 'w2': _w((lambda *s: torch.randn(*s, dtype=torch.bfloat16) * 0.05)(Dff, D))}
    _B_in = _B_setup()
    return {'A_x': _A_in['x'], 'A_wqkv': _A_in['wqkv'], 'A_wo': _A_in['wo'], 'B_x': _B_in['x'], 'B_w1': _B_in['w1'], 'B_w2': _B_in['w2'], 'c': _w((lambda *s: torch.randn(*s, dtype=torch.bfloat16) * 0.1)(1, 448) * 8.0), 'w_mod': _w((lambda *s: torch.randn(*s, dtype=torch.bfloat16) * 0.1)(448, 6 * 448) * 448 ** (-0.5) * 8.0)}

def reference(A_x, A_wqkv, A_wo, B_x, B_w1, B_w2, c, w_mod):

    def _A_ref(x, wqkv, wo):
        B, S, D = x.shape
        H = 16
        Dh = D // H
        W = 256
        qkv = (lambda x, *d: x.permute(*d))((x @ wqkv).reshape(B, S, 3, H, Dh), 2, 0, 3, 1, 4)
        q, k, v = (qkv[0], qkv[1], qkv[2])
        scores = torch.einsum('bhqd,bhkd->bhqk', q, k) * Dh ** (-0.5)
        idx = torch.arange(S)
        mask = (idx[:, None] - idx[None, :] >= 0) & (idx[:, None] - idx[None, :] < W)
        scores = torch.where(mask[None, None], scores, -1000000000.0)
        p = _softmax(scores, axis=-1)
        o = torch.einsum('bhqk,bhkd->bhqd', p, v)
        return (lambda x, *d: x.permute(*d))(o, 0, 2, 1, 3).reshape(B, S, D) @ wo

    def _B_ref(x, w1, w2):
        h = torch.einsum('bsd,df->bsf', x, w1)
        zero = torch.zeros_like(h)
        h = torch.maximum(h, zero)
        return torch.einsum('bsf,fd->bsd', h, w2)
    x = A_x
    mod = (_silu(c) @ w_mod).reshape(c.shape[0], 6, 1, -1)
    sa, ca, ga, sb, cb, gb = (mod[:, 0].clone(), mod[:, 1].clone(), mod[:, 2].clone(), mod[:, 3].clone(), mod[:, 4].clone(), mod[:, 5].clone())
    h = _layernorm(x, axis=-1) * (1 + ca) + sa
    x = x + ga * _A_ref(h, A_wqkv, A_wo)
    h = _layernorm(x, axis=-1) * (1 + cb) + sb
    x = x + gb * _B_ref(h, B_w1, B_w2)
    return x
```

```asm
; @launch kernel=adaLN_cond__sliding_block__dense_activation_relu__prompt_kernel grid=(256,1,1) block=(512,1,1) lds=137216
.amdgcn_target "amdgcn-amd-amdhsa--gfx950"
.text
.globl adaLN_cond__sliding_block__dense_activation_relu__prompt_kernel
.p2align 8
.type adaLN_cond__sliding_block__dense_activation_relu__prompt_kernel,@function
adaLN_cond__sliding_block__dense_activation_relu__prompt_kernel:
    s_cmp_ge_u32 s2, 256
    s_cbranch_scc1 KM_exit
    s_load_dwordx16 s[64:79], s[0:1], 0
    s_load_dwordx4 s[28:31], s[0:1], 64
    s_load_dwordx2 s[4:5], s[0:1], 80
    v_lshrrev_b32 v3, 6, v0
    v_and_b32 v1, 63, v0
    v_readfirstlane_b32 s26, v3
    v_lshlrev_b32 v2, 4, v1
    s_and_b32 s32, s2, 7
    s_lshr_b32 s33, s2, 3
    s_and_b32 s25, s33, 15
    s_lshr_b32 s33, s33, 4
    s_lshl_b32 s33, s33, 3
    s_add_u32 s24, s32, s33
    s_waitcnt lgkmcnt(0)
    s_mov_b32 s8, s4
    s_and_b32 s9, s5, 0xffff
    s_mov_b32 s10, 268435456
    s_mov_b32 s11, 0x00020000
    s_mov_b32 s12, s64
    s_and_b32 s13, s65, 0xffff
    s_mov_b32 s14, 1835008
    s_mov_b32 s15, 0x00020000
    s_mov_b32 s16, s28
    s_and_b32 s17, s29, 0xffff
    s_mov_b32 s18, 1835008
    s_mov_b32 s19, 0x00020000
    s_mov_b32 s20, s30
    s_and_b32 s21, s31, 0xffff
    s_mov_b32 s22, 256
    s_mov_b32 s23, 0x00020000
    s_cmp_lg_u32 s2, 0
    s_cbranch_scc1 KM_noinit
    s_cmp_lg_u32 s26, 0
    s_cbranch_scc1 KM_noinit
    v_lshlrev_b32 v3, 9, v1
    v_mov_b32 v4, 0
    s_mov_b32 s40, 32505856
    buffer_store_dword v4, v3, s[8:11], s40 offen sc1
    s_mov_b32 s40, 32538624
    buffer_store_dword v4, v3, s[8:11], s40 offen sc1
    s_mov_b32 s40, 32571392
    buffer_store_dword v4, v3, s[8:11], s40 offen sc1
    s_mov_b32 s40, 32604160
    buffer_store_dword v4, v3, s[8:11], s40 offen sc1
    s_mov_b32 s40, 32636928
    buffer_store_dword v4, v3, s[8:11], s40 offen sc1
    s_mov_b32 s40, 32669696
    buffer_store_dword v4, v3, s[8:11], s40 offen sc1
    s_waitcnt vmcnt(0)
    v_mov_b32 v4, 1
    v_mov_b32 v3, 0
    s_mov_b64 s[40:41], exec
    s_mov_b64 exec, 1
    buffer_store_dword v4, v3, s[20:23], 0 offen sc1
    s_mov_b64 exec, s[40:41]
KM_noinit:
    s_cmp_ge_u32 s2, 42
    s_cbranch_scc1 KM_mi
    s_cmp_lt_u32 s26, 4
    s_cbranch_scc1 KM_mi
    v_and_b32 v72, 7, v0
    v_bfe_u32 v73, v0, 3, 5
    s_movk_i32 s40, 5376
    v_mul_lo_u32 v74, v73, s40
    v_lshl_add_u32 v74, v72, 4, v74
    s_lshl_b32 s41, s2, 7
    v_add_u32 v74, s41, v74
    v_lshlrev_b32 v75, 1, v73
    s_mov_b32 s44, s78
    s_and_b32 s45, s79, 0xffff
    s_mov_b32 s46, 2408448
    s_mov_b32 s47, 0x00020000
    s_mov_b32 s48, s76
    s_and_b32 s49, s77, 0xffff
    s_mov_b32 s50, 896
    s_mov_b32 s51, 0x00020000
    buffer_load_ushort v80, v75, s[48:51], 0 offen offset:0
    buffer_load_ushort v81, v75, s[48:51], 0 offen offset:64
    buffer_load_ushort v82, v75, s[48:51], 0 offen offset:128
    buffer_load_ushort v83, v75, s[48:51], 0 offen offset:192
    buffer_load_ushort v84, v75, s[48:51], 0 offen offset:256
    buffer_load_ushort v85, v75, s[48:51], 0 offen offset:320
    buffer_load_ushort v86, v75, s[48:51], 0 offen offset:384
    buffer_load_ushort v87, v75, s[48:51], 0 offen offset:448
    buffer_load_ushort v88, v75, s[48:51], 0 offen offset:512
    buffer_load_ushort v89, v75, s[48:51], 0 offen offset:576
    buffer_load_ushort v90, v75, s[48:51], 0 offen offset:640
    buffer_load_ushort v91, v75, s[48:51], 0 offen offset:704
    buffer_load_ushort v92, v75, s[48:51], 0 offen offset:768
    buffer_load_ushort v93, v75, s[48:51], 0 offen offset:832
    s_mov_b32 s40, 0
    buffer_load_dwordx4 v[96:99], v74, s[44:47], s40 offen
    s_mov_b32 s40, 172032
    buffer_load_dwordx4 v[100:103], v74, s[44:47], s40 offen
    s_mov_b32 s40, 344064
    buffer_load_dwordx4 v[104:107], v74, s[44:47], s40 offen
    s_mov_b32 s40, 516096
    buffer_load_dwordx4 v[108:111], v74, s[44:47], s40 offen
    s_mov_b32 s40, 688128
    buffer_load_dwordx4 v[112:115], v74, s[44:47], s40 offen
    s_mov_b32 s40, 860160
    buffer_load_dwordx4 v[116:119], v74, s[44:47], s40 offen
    s_mov_b32 s40, 1032192
    buffer_load_dwordx4 v[120:123], v74, s[44:47], s40 offen
    s_mov_b32 s40, 1204224
    buffer_load_dwordx4 v[124:127], v74, s[44:47], s40 offen
    s_mov_b32 s40, 1376256
    buffer_load_dwordx4 v[128:131], v74, s[44:47], s40 offen
    s_mov_b32 s40, 1548288
    buffer_load_dwordx4 v[132:135], v74, s[44:47], s40 offen
    s_mov_b32 s40, 1720320
    buffer_load_dwordx4 v[136:139], v74, s[44:47], s40 offen
    s_mov_b32 s40, 1892352
    buffer_load_dwordx4 v[140:143], v74, s[44:47], s40 offen
    s_mov_b32 s40, 2064384
    buffer_load_dwordx4 v[144:147], v74, s[44:47], s40 offen
    s_mov_b32 s40, 2236416
    buffer_load_dwordx4 v[148:151], v74, s[44:47], s40 offen
KM_mi:
    s_mov_b32 s55, -1
    s_cmp_lt_u32 s2, 42
    s_cbranch_scc1 KM_ln0
    s_cmp_eq_u32 s26, 1
    s_cselect_b32 s55, s2, -1
    s_cmp_ge_u32 s2, 84
    s_cbranch_scc1 KM_lnsel
    s_sub_u32 s40, s2, 42
    s_cmp_eq_u32 s26, 2
    s_cselect_b32 s55, s40, s55
KM_lnsel:
    s_cmp_eq_u32 s55, -1
    s_cbranch_scc1 KM_ln0
    v_and_b32 v72, 7, v1
    v_lshrrev_b32 v73, 3, v1
    s_lshl_b32 s40, s55, 3
    v_add_u32 v74, s40, v73
    s_movk_i32 s41, 896
    v_mul_lo_u32 v75, v74, s41
    v_lshl_add_u32 v75, v72, 4, v75
    buffer_load_dwordx4 v[80:83], v75, s[12:15], 0 offen offset:0
    buffer_load_dwordx4 v[84:87], v75, s[12:15], 0 offen offset:128
    buffer_load_dwordx4 v[88:91], v75, s[12:15], 0 offen offset:256
    buffer_load_dwordx4 v[92:95], v75, s[12:15], 0 offen offset:384
    buffer_load_dwordx4 v[96:99], v75, s[12:15], 0 offen offset:512
    buffer_load_dwordx4 v[100:103], v75, s[12:15], 0 offen offset:640
    buffer_load_dwordx4 v[104:107], v75, s[12:15], 0 offen offset:768
KM_ln0:
    s_cmp_eq_u32 s55, -1
    s_cbranch_scc1 KM_ln1
    v_lshrrev_b32 v76, 1, v72
    v_lshlrev_b32 v76, 10, v76
    v_and_b32 v77, 1, v72
    v_lshl_add_u32 v76, v77, 9, v76
    v_and_b32 v77, 31, v74
    v_lshl_add_u32 v76, v77, 4, v76
    s_lshr_b32 s40, s55, 2
    s_mul_i32 s41, s40, 28672
    s_add_u32 s41, s41, 65536
    v_mov_b32 v77, 0
    s_waitcnt vmcnt(0)
    v_lshlrev_b32 v108, 16, v80
    v_and_b32 v109, 0xffff0000, v80
    v_add_f32 v77, v77, v108
    v_add_f32 v77, v77, v109
    v_lshlrev_b32 v110, 16, v81
    v_and_b32 v111, 0xffff0000, v81
    v_add_f32 v77, v77, v110
    v_add_f32 v77, v77, v111
    v_lshlrev_b32 v112, 16, v82
    v_and_b32 v113, 0xffff0000, v82
    v_add_f32 v77, v77, v112
    v_add_f32 v77, v77, v113
    v_lshlrev_b32 v114, 16, v83
    v_and_b32 v115, 0xffff0000, v83
    v_add_f32 v77, v77, v114
    v_add_f32 v77, v77, v115
    v_lshlrev_b32 v116, 16, v84
    v_and_b32 v117, 0xffff0000, v84
    v_add_f32 v77, v77, v116
    v_add_f32 v77, v77, v117
    v_lshlrev_b32 v118, 16, v85
    v_and_b32 v119, 0xffff0000, v85
    v_add_f32 v77, v77, v118
    v_add_f32 v77, v77, v119
    v_lshlrev_b32 v120, 16, v86
    v_and_b32 v121, 0xffff0000, v86
    v_add_f32 v77, v77, v120
    v_add_f32 v77, v77, v121
    v_lshlrev_b32 v122, 16, v87
    v_and_b32 v123, 0xffff0000, v87
    v_add_f32 v77, v77, v122
    v_add_f32 v77, v77, v123
    v_lshlrev_b32 v124, 16, v88
    v_and_b32 v125, 0xffff0000, v88
    v_add_f32 v77, v77, v124
    v_add_f32 v77, v77, v125
    v_lshlrev_b32 v126, 16, v89
    v_and_b32 v127, 0xffff0000, v89
    v_add_f32 v77, v77, v126
    v_add_f32 v77, v77, v127
    v_lshlrev_b32 v128, 16, v90
    v_and_b32 v129, 0xffff0000, v90
    v_add_f32 v77, v77, v128
    v_add_f32 v77, v77, v129
    v_lshlrev_b32 v130, 16, v91
    v_and_b32 v131, 0xffff0000, v91
    v_add_f32 v77, v77, v130
    v_add_f32 v77, v77, v131
    v_lshlrev_b32 v132, 16, v92
    v_and_b32 v133, 0xffff0000, v92
    v_add_f32 v77, v77, v132
    v_add_f32 v77, v77, v133
    v_lshlrev_b32 v134, 16, v93
    v_and_b32 v135, 0xffff0000, v93
    v_add_f32 v77, v77, v134
    v_add_f32 v77, v77, v135
    v_lshlrev_b32 v136, 16, v94
    v_and_b32 v137, 0xffff0000, v94
    v_add_f32 v77, v77, v136
    v_add_f32 v77, v77, v137
    v_lshlrev_b32 v138, 16, v95
    v_and_b32 v139, 0xffff0000, v95
    v_add_f32 v77, v77, v138
    v_add_f32 v77, v77, v139
    v_lshlrev_b32 v140, 16, v96
    v_and_b32 v141, 0xffff0000, v96
    v_add_f32 v77, v77, v140
    v_add_f32 v77, v77, v141
    v_lshlrev_b32 v142, 16, v97
    v_and_b32 v143, 0xffff0000, v97
    v_add_f32 v77, v77, v142
    v_add_f32 v77, v77, v143
    v_lshlrev_b32 v144, 16, v98
    v_and_b32 v145, 0xffff0000, v98
    v_add_f32 v77, v77, v144
    v_add_f32 v77, v77, v145
    v_lshlrev_b32 v146, 16, v99
    v_and_b32 v147, 0xffff0000, v99
    v_add_f32 v77, v77, v146
    v_add_f32 v77, v77, v147
    v_lshlrev_b32 v148, 16, v100
    v_and_b32 v149, 0xffff0000, v100
    v_add_f32 v77, v77, v148
    v_add_f32 v77, v77, v149
    v_lshlrev_b32 v150, 16, v101
    v_and_b32 v151, 0xffff0000, v101
    v_add_f32 v77, v77, v150
    v_add_f32 v77, v77, v151
    v_lshlrev_b32 v152, 16, v102
    v_and_b32 v153, 0xffff0000, v102
    v_add_f32 v77, v77, v152
    v_add_f32 v77, v77, v153
    v_lshlrev_b32 v154, 16, v103
    v_and_b32 v155, 0xffff0000, v103
    v_add_f32 v77, v77, v154
    v_add_f32 v77, v77, v155
    v_lshlrev_b32 v156, 16, v104
    v_and_b32 v157, 0xffff0000, v104
    v_add_f32 v77, v77, v156
    v_add_f32 v77, v77, v157
    v_lshlrev_b32 v158, 16, v105
    v_and_b32 v159, 0xffff0000, v105
    v_add_f32 v77, v77, v158
    v_add_f32 v77, v77, v159
    v_lshlrev_b32 v160, 16, v106
    v_and_b32 v161, 0xffff0000, v106
    v_add_f32 v77, v77, v160
    v_add_f32 v77, v77, v161
    v_lshlrev_b32 v162, 16, v107
    v_and_b32 v163, 0xffff0000, v107
    v_add_f32 v77, v77, v162
    v_add_f32 v77, v77, v163
    s_nop 1
    v_add_f32_dpp v77, v77, v77 quad_perm:[1,0,3,2] row_mask:0xf bank_mask:0xf
    s_nop 1
    v_add_f32_dpp v77, v77, v77 quad_perm:[2,3,0,1] row_mask:0xf bank_mask:0xf
    s_nop 1
    v_add_f32_dpp v77, v77, v77 row_half_mirror row_mask:0xf bank_mask:0xf
    v_mul_f32 v77, 0x3b124925, v77
    v_mov_b32 v78, 0
    v_sub_f32 v79, v108, v77
    v_fmac_f32 v78, v79, v79
    v_sub_f32 v79, v109, v77
    v_fmac_f32 v78, v79, v79
    v_sub_f32 v79, v110, v77
    v_fmac_f32 v78, v79, v79
    v_sub_f32 v79, v111, v77
    v_fmac_f32 v78, v79, v79
    v_sub_f32 v79, v112, v77
    v_fmac_f32 v78, v79, v79
    v_sub_f32 v79, v113, v77
    v_fmac_f32 v78, v79, v79
    v_sub_f32 v79, v114, v77
    v_fmac_f32 v78, v79, v79
    v_sub_f32 v79, v115, v77
    v_fmac_f32 v78, v79, v79
    v_sub_f32 v79, v116, v77
    v_fmac_f32 v78, v79, v79
    v_sub_f32 v79, v117, v77
    v_fmac_f32 v78, v79, v79
    v_sub_f32 v79, v118, v77
    v_fmac_f32 v78, v79, v79
    v_sub_f32 v79, v119, v77
    v_fmac_f32 v78, v79, v79
    v_sub_f32 v79, v120, v77
    v_fmac_f32 v78, v79, v79
    v_sub_f32 v79, v121, v77
    v_fmac_f32 v78, v79, v79
    v_sub_f32 v79, v122, v77
    v_fmac_f32 v78, v79, v79
    v_sub_f32 v79, v123, v77
    v_fmac_f32 v78, v79, v79
    v_sub_f32 v79, v124, v77
    v_fmac_f32 v78, v79, v79
    v_sub_f32 v79, v125, v77
    v_fmac_f32 v78, v79, v79
    v_sub_f32 v79, v126, v77
    v_fmac_f32 v78, v79, v79
    v_sub_f32 v79, v127, v77
    v_fmac_f32 v78, v79, v79
    v_sub_f32 v79, v128, v77
    v_fmac_f32 v78, v79, v79
    v_sub_f32 v79, v129, v77
    v_fmac_f32 v78, v79, v79
    v_sub_f32 v79, v130, v77
    v_fmac_f32 v78, v79, v79
    v_sub_f32 v79, v131, v77
    v_fmac_f32 v78, v79, v79
    v_sub_f32 v79, v132, v77
    v_fmac_f32 v78, v79, v79
    v_sub_f32 v79, v133, v77
    v_fmac_f32 v78, v79, v79
    v_sub_f32 v79, v134, v77
    v_fmac_f32 v78, v79, v79
    v_sub_f32 v79, v135, v77
    v_fmac_f32 v78, v79, v79
    v_sub_f32 v79, v136, v77
    v_fmac_f32 v78, v79, v79
    v_sub_f32 v79, v137, v77
    v_fmac_f32 v78, v79, v79
    v_sub_f32 v79, v138, v77
    v_fmac_f32 v78, v79, v79
    v_sub_f32 v79, v139, v77
    v_fmac_f32 v78, v79, v79
    v_sub_f32 v79, v140, v77
    v_fmac_f32 v78, v79, v79
    v_sub_f32 v79, v141, v77
    v_fmac_f32 v78, v79, v79
    v_sub_f32 v79, v142, v77
    v_fmac_f32 v78, v79, v79
    v_sub_f32 v79, v143, v77
    v_fmac_f32 v78, v79, v79
    v_sub_f32 v79, v144, v77
    v_fmac_f32 v78, v79, v79
    v_sub_f32 v79, v145, v77
    v_fmac_f32 v78, v79, v79
    v_sub_f32 v79, v146, v77
    v_fmac_f32 v78, v79, v79
    v_sub_f32 v79, v147, v77
    v_fmac_f32 v78, v79, v79
    v_sub_f32 v79, v148, v77
    v_fmac_f32 v78, v79, v79
    v_sub_f32 v79, v149, v77
    v_fmac_f32 v78, v79, v79
    v_sub_f32 v79, v150, v77
    v_fmac_f32 v78, v79, v79
    v_sub_f32 v79, v151, v77
    v_fmac_f32 v78, v79, v79
    v_sub_f32 v79, v152, v77
    v_fmac_f32 v78, v79, v79
    v_sub_f32 v79, v153, v77
    v_fmac_f32 v78, v79, v79
    v_sub_f32 v79, v154, v77
    v_fmac_f32 v78, v79, v79
    v_sub_f32 v79, v155, v77
    v_fmac_f32 v78, v79, v79
    v_sub_f32 v79, v156, v77
    v_fmac_f32 v78, v79, v79
    v_sub_f32 v79, v157, v77
    v_fmac_f32 v78, v79, v79
    v_sub_f32 v79, v158, v77
    v_fmac_f32 v78, v79, v79
    v_sub_f32 v79, v159, v77
    v_fmac_f32 v78, v79, v79
    v_sub_f32 v79, v160, v77
    v_fmac_f32 v78, v79, v79
    v_sub_f32 v79, v161, v77
    v_fmac_f32 v78, v79, v79
    v_sub_f32 v79, v162, v77
    v_fmac_f32 v78, v79, v79
    v_sub_f32 v79, v163, v77
    v_fmac_f32 v78, v79, v79
    s_nop 1
    v_add_f32_dpp v78, v78, v78 quad_perm:[1,0,3,2] row_mask:0xf bank_mask:0xf
    s_nop 1
    v_add_f32_dpp v78, v78, v78 quad_perm:[2,3,0,1] row_mask:0xf bank_mask:0xf
    s_nop 1
    v_add_f32_dpp v78, v78, v78 row_half_mirror row_mask:0xf bank_mask:0xf
    v_mul_f32 v78, 0x3b124925, v78
    v_cvt_pk_bf16_f32 v78, v78, v78
    v_lshlrev_b32 v78, 16, v78
    v_add_f32 v78, 0x3727c5ac, v78
    v_cvt_pk_bf16_f32 v78, v78, v78
    v_lshlrev_b32 v78, 16, v78
    v_sqrt_f32 v78, v78
    s_nop 0
    v_cvt_pk_bf16_f32 v78, v78, v78
    v_lshlrev_b32 v78, 16, v78
    v_rcp_f32 v78, v78
    v_cvt_pk_bf16_f32 v77, v77, v77
    v_lshlrev_b32 v77, 16, v77
    v_sub_f32 v108, v108, v77
    v_sub_f32 v109, v109, v77
    v_cvt_pk_bf16_f32 v79, v108, v109
    v_lshlrev_b32 v108, 16, v79
    v_and_b32 v109, 0xffff0000, v79
    v_mul_f32 v108, v108, v78
    v_mul_f32 v109, v109, v78
    v_cvt_pk_bf16_f32 v80, v108, v109
    v_sub_f32 v110, v110, v77
    v_sub_f32 v111, v111, v77
    v_cvt_pk_bf16_f32 v79, v110, v111
    v_lshlrev_b32 v110, 16, v79
    v_and_b32 v111, 0xffff0000, v79
    v_mul_f32 v110, v110, v78
    v_mul_f32 v111, v111, v78
    v_cvt_pk_bf16_f32 v81, v110, v111
    v_sub_f32 v112, v112, v77
    v_sub_f32 v113, v113, v77
    v_cvt_pk_bf16_f32 v79, v112, v113
    v_lshlrev_b32 v112, 16, v79
    v_and_b32 v113, 0xffff0000, v79
    v_mul_f32 v112, v112, v78
    v_mul_f32 v113, v113, v78
    v_cvt_pk_bf16_f32 v82, v112, v113
    v_sub_f32 v114, v114, v77
    v_sub_f32 v115, v115, v77
    v_cvt_pk_bf16_f32 v79, v114, v115
    v_lshlrev_b32 v114, 16, v79
    v_and_b32 v115, 0xffff0000, v79
    v_mul_f32 v114, v114, v78
    v_mul_f32 v115, v115, v78
    v_cvt_pk_bf16_f32 v83, v114, v115
    s_add_u32 s40, s41, 0
    buffer_store_dwordx4 v[80:83], v76, s[8:11], s40 offen sc1
    v_sub_f32 v116, v116, v77
    v_sub_f32 v117, v117, v77
    v_cvt_pk_bf16_f32 v79, v116, v117
    v_lshlrev_b32 v116, 16, v79
    v_and_b32 v117, 0xffff0000, v79
    v_mul_f32 v116, v116, v78
    v_mul_f32 v117, v117, v78
    v_cvt_pk_bf16_f32 v84, v116, v117
    v_sub_f32 v118, v118, v77
    v_sub_f32 v119, v119, v77
    v_cvt_pk_bf16_f32 v79, v118, v119
    v_lshlrev_b32 v118, 16, v79
    v_and_b32 v119, 0xffff0000, v79
    v_mul_f32 v118, v118, v78
    v_mul_f32 v119, v119, v78
    v_cvt_pk_bf16_f32 v85, v118, v119
    v_sub_f32 v120, v120, v77
    v_sub_f32 v121, v121, v77
    v_cvt_pk_bf16_f32 v79, v120, v121
    v_lshlrev_b32 v120, 16, v79
    v_and_b32 v121, 0xffff0000, v79
    v_mul_f32 v120, v120, v78
    v_mul_f32 v121, v121, v78
    v_cvt_pk_bf16_f32 v86, v120, v121
    v_sub_f32 v122, v122, v77
    v_sub_f32 v123, v123, v77
    v_cvt_pk_bf16_f32 v79, v122, v123
    v_lshlrev_b32 v122, 16, v79
    v_and_b32 v123, 0xffff0000, v79
    v_mul_f32 v122, v122, v78
    v_mul_f32 v123, v123, v78
    v_cvt_pk_bf16_f32 v87, v122, v123
    s_add_u32 s40, s41, 4096
    buffer_store_dwordx4 v[84:87], v76, s[8:11], s40 offen sc1
    v_sub_f32 v124, v124, v77
    v_sub_f32 v125, v125, v77
    v_cvt_pk_bf16_f32 v79, v124, v125
    v_lshlrev_b32 v124, 16, v79
    v_and_b32 v125, 0xffff0000, v79
    v_mul_f32 v124, v124, v78
    v_mul_f32 v125, v125, v78
    v_cvt_pk_bf16_f32 v88, v124, v125
    v_sub_f32 v126, v126, v77
    v_sub_f32 v127, v127, v77
    v_cvt_pk_bf16_f32 v79, v126, v127
    v_lshlrev_b32 v126, 16, v79
    v_and_b32 v127, 0xffff0000, v79
    v_mul_f32 v126, v126, v78
    v_mul_f32 v127, v127, v78
    v_cvt_pk_bf16_f32 v89, v126, v127
    v_sub_f32 v128, v128, v77
    v_sub_f32 v129, v129, v77
    v_cvt_pk_bf16_f32 v79, v128, v129
    v_lshlrev_b32 v128, 16, v79
    v_and_b32 v129, 0xffff0000, v79
    v_mul_f32 v128, v128, v78
    v_mul_f32 v129, v129, v78
    v_cvt_pk_bf16_f32 v90, v128, v129
    v_sub_f32 v130, v130, v77
    v_sub_f32 v131, v131, v77
    v_cvt_pk_bf16_f32 v79, v130, v131
    v_lshlrev_b32 v130, 16, v79
    v_and_b32 v131, 0xffff0000, v79
    v_mul_f32 v130, v130, v78
    v_mul_f32 v131, v131, v78
    v_cvt_pk_bf16_f32 v91, v130, v131
    s_add_u32 s40, s41, 8192
    buffer_store_dwordx4 v[88:91], v76, s[8:11], s40 offen sc1
    v_sub_f32 v132, v132, v77
    v_sub_f32 v133, v133, v77
    v_cvt_pk_bf16_f32 v79, v132, v133
    v_lshlrev_b32 v132, 16, v79
    v_and_b32 v133, 0xffff0000, v79
    v_mul_f32 v132, v132, v78
    v_mul_f32 v133, v133, v78
    v_cvt_pk_bf16_f32 v92, v132, v133
    v_sub_f32 v134, v134, v77
    v_sub_f32 v135, v135, v77
    v_cvt_pk_bf16_f32 v79, v134, v135
    v_lshlrev_b32 v134, 16, v79
    v_and_b32 v135, 0xffff0000, v79
    v_mul_f32 v134, v134, v78
    v_mul_f32 v135, v135, v78
    v_cvt_pk_bf16_f32 v93, v134, v135
    v_sub_f32 v136, v136, v77
    v_sub_f32 v137, v137, v77
    v_cvt_pk_bf16_f32 v79, v136, v137
    v_lshlrev_b32 v136, 16, v79
    v_and_b32 v137, 0xffff0000, v79
    v_mul_f32 v136, v136, v78
    v_mul_f32 v137, v137, v78
    v_cvt_pk_bf16_f32 v94, v136, v137
    v_sub_f32 v138, v138, v77
    v_sub_f32 v139, v139, v77
    v_cvt_pk_bf16_f32 v79, v138, v139
    v_lshlrev_b32 v138, 16, v79
    v_and_b32 v139, 0xffff0000, v79
    v_mul_f32 v138, v138, v78
    v_mul_f32 v139, v139, v78
    v_cvt_pk_bf16_f32 v95, v138, v139
    s_add_u32 s40, s41, 12288
    buffer_store_dwordx4 v[92:95], v76, s[8:11], s40 offen sc1
    v_sub_f32 v140, v140, v77
    v_sub_f32 v141, v141, v77
    v_cvt_pk_bf16_f32 v79, v140, v141
    v_lshlrev_b32 v140, 16, v79
    v_and_b32 v141, 0xffff0000, v79
    v_mul_f32 v140, v140, v78
    v_mul_f32 v141, v141, v78
    v_cvt_pk_bf16_f32 v96, v140, v141
    v_sub_f32 v142, v142, v77
    v_sub_f32 v143, v143, v77
    v_cvt_pk_bf16_f32 v79, v142, v143
    v_lshlrev_b32 v142, 16, v79
    v_and_b32 v143, 0xffff0000, v79
    v_mul_f32 v142, v142, v78
    v_mul_f32 v143, v143, v78
    v_cvt_pk_bf16_f32 v97, v142, v143
    v_sub_f32 v144, v144, v77
    v_sub_f32 v145, v145, v77
    v_cvt_pk_bf16_f32 v79, v144, v145
    v_lshlrev_b32 v144, 16, v79
    v_and_b32 v145, 0xffff0000, v79
    v_mul_f32 v144, v144, v78
    v_mul_f32 v145, v145, v78
    v_cvt_pk_bf16_f32 v98, v144, v145
    v_sub_f32 v146, v146, v77
    v_sub_f32 v147, v147, v77
    v_cvt_pk_bf16_f32 v79, v146, v147
    v_lshlrev_b32 v146, 16, v79
    v_and_b32 v147, 0xffff0000, v79
    v_mul_f32 v146, v146, v78
    v_mul_f32 v147, v147, v78
    v_cvt_pk_bf16_f32 v99, v146, v147
    s_add_u32 s40, s41, 16384
    buffer_store_dwordx4 v[96:99], v76, s[8:11], s40 offen sc1
    v_sub_f32 v148, v148, v77
    v_sub_f32 v149, v149, v77
    v_cvt_pk_bf16_f32 v79, v148, v149
    v_lshlrev_b32 v148, 16, v79
    v_and_b32 v149, 0xffff0000, v79
    v_mul_f32 v148, v148, v78
    v_mul_f32 v149, v149, v78
    v_cvt_pk_bf16_f32 v100, v148, v149
    v_sub_f32 v150, v150, v77
    v_sub_f32 v151, v151, v77
    v_cvt_pk_bf16_f32 v79, v150, v151
    v_lshlrev_b32 v150, 16, v79
    v_and_b32 v151, 0xffff0000, v79
    v_mul_f32 v150, v150, v78
    v_mul_f32 v151, v151, v78
    v_cvt_pk_bf16_f32 v101, v150, v151
    v_sub_f32 v152, v152, v77
    v_sub_f32 v153, v153, v77
    v_cvt_pk_bf16_f32 v79, v152, v153
    v_lshlrev_b32 v152, 16, v79
    v_and_b32 v153, 0xffff0000, v79
    v_mul_f32 v152, v152, v78
    v_mul_f32 v153, v153, v78
    v_cvt_pk_bf16_f32 v102, v152, v153
    v_sub_f32 v154, v154, v77
    v_sub_f32 v155, v155, v77
    v_cvt_pk_bf16_f32 v79, v154, v155
    v_lshlrev_b32 v154, 16, v79
    v_and_b32 v155, 0xffff0000, v79
    v_mul_f32 v154, v154, v78
    v_mul_f32 v155, v155, v78
    v_cvt_pk_bf16_f32 v103, v154, v155
    s_add_u32 s40, s41, 20480
    buffer_store_dwordx4 v[100:103], v76, s[8:11], s40 offen sc1
    v_sub_f32 v156, v156, v77
    v_sub_f32 v157, v157, v77
    v_cvt_pk_bf16_f32 v79, v156, v157
    v_lshlrev_b32 v156, 16, v79
    v_and_b32 v157, 0xffff0000, v79
    v_mul_f32 v156, v156, v78
    v_mul_f32 v157, v157, v78
    v_cvt_pk_bf16_f32 v104, v156, v157
    v_sub_f32 v158, v158, v77
    v_sub_f32 v159, v159, v77
    v_cvt_pk_bf16_f32 v79, v158, v159
    v_lshlrev_b32 v158, 16, v79
    v_and_b32 v159, 0xffff0000, v79
    v_mul_f32 v158, v158, v78
    v_mul_f32 v159, v159, v78
    v_cvt_pk_bf16_f32 v105, v158, v159
    v_sub_f32 v160, v160, v77
    v_sub_f32 v161, v161, v77
    v_cvt_pk_bf16_f32 v79, v160, v161
    v_lshlrev_b32 v160, 16, v79
    v_and_b32 v161, 0xffff0000, v79
    v_mul_f32 v160, v160, v78
    v_mul_f32 v161, v161, v78
    v_cvt_pk_bf16_f32 v106, v160, v161
    v_sub_f32 v162, v162, v77
    v_sub_f32 v163, v163, v77
    v_cvt_pk_bf16_f32 v79, v162, v163
    v_lshlrev_b32 v162, 16, v79
    v_and_b32 v163, 0xffff0000, v79
    v_mul_f32 v162, v162, v78
    v_mul_f32 v163, v163, v78
    v_cvt_pk_bf16_f32 v107, v162, v163
    s_add_u32 s40, s41, 24576
    buffer_store_dwordx4 v[104:107], v76, s[8:11], s40 offen sc1
    v_mov_b32 v3, 0
    s_mov_b32 s40, 0
INI1_loop:
    buffer_load_dword v4, v3, s[20:23], 0 offen sc1
    s_waitcnt vmcnt(0)
    v_readfirstlane_b32 s44, v4
    s_add_u32 s40, s40, 1
    s_cmp_ge_u32 s40, 0x40000
    s_cbranch_scc1 INI1_done
    s_cmp_eq_u32 s44, 1
    s_cbranch_scc1 INI1_done
    s_sleep 8
    s_branch INI1_loop
INI1_done:
    s_mov_b64 s[42:43], exec
    s_mov_b64 exec, 1
    v_mov_b32 v3, 0
    v_mov_b32 v4, 1
    s_lshr_b32 s41, s55, 4
    s_lshl_b32 s41, s41, 9
    s_add_u32 s41, s41, 32546816
    buffer_atomic_add v4, v3, s[8:11], s41 offen
    s_mov_b64 exec, s[42:43]
KM_ln1:
    v_add_u32 v4, 0, v1
    v_mul_u32_u24 v5, 43691, v4
    v_lshrrev_b32 v5, 19, v5
    v_mul_u32_u24 v6, 12, v5
    v_sub_u32 v6, v4, v6
    v_mul_u32_u24 v5, 2688, v5
    v_lshl_add_u32 v8, v6, 4, v5
    v_add_u32 v4, 64, v1
    v_mul_u32_u24 v5, 43691, v4
    v_lshrrev_b32 v5, 19, v5
    v_mul_u32_u24 v6, 12, v5
    v_sub_u32 v6, v4, v6
    v_mul_u32_u24 v5, 2688, v5
    v_lshl_add_u32 v9, v6, 4, v5
    v_add_u32 v4, 128, v1
    v_mul_u32_u24 v5, 43691, v4
    v_lshrrev_b32 v5, 19, v5
    v_mul_u32_u24 v6, 12, v5
    v_sub_u32 v6, v4, v6
    v_mul_u32_u24 v5, 2688, v5
    v_lshl_add_u32 v10, v6, 4, v5
    s_mov_b32 s44, s66
    s_and_b32 s45, s67, 0xffff
    s_mov_b32 s46, 1204224
    s_mov_b32 s47, 0x00020000
    s_mul_i32 s38, s25, 168
    s_add_u32 s39, s26, 0
    s_mul_i32 s40, s39, 43008
    s_add_u32 s40, s40, s38
    s_mul_i32 s39, s39, 3072
    s_add_u32 s41, s39, 0
    s_mov_b32 m0, s41
    s_nop 0
    buffer_load_dwordx4 v8, s[44:47], s40 offen lds
    s_add_u32 s41, s39, 1024
    s_mov_b32 m0, s41
    s_nop 0
    buffer_load_dwordx4 v9, s[44:47], s40 offen lds
    s_add_u32 s41, s39, 2048
    s_mov_b32 m0, s41
    s_nop 0
    buffer_load_dwordx4 v10, s[44:47], s40 offen lds
    s_add_u32 s39, s26, 8
    s_mul_i32 s40, s39, 43008
    s_add_u32 s40, s40, s38
    s_mul_i32 s39, s39, 3072
    s_add_u32 s41, s39, 0
    s_mov_b32 m0, s41
    s_nop 0
    buffer_load_dwordx4 v8, s[44:47], s40 offen lds
    s_add_u32 s41, s39, 1024
    s_mov_b32 m0, s41
    s_nop 0
    buffer_load_dwordx4 v9, s[44:47], s40 offen lds
    s_add_u32 s41, s39, 2048
    s_mov_b32 m0, s41
    s_nop 0
    buffer_load_dwordx4 v10, s[44:47], s40 offen lds
    s_add_u32 s39, s26, 16
    s_mul_i32 s40, s39, 43008
    s_add_u32 s40, s40, s38
    s_mul_i32 s39, s39, 3072
    s_add_u32 s41, s39, 0
    s_mov_b32 m0, s41
    s_nop 0
    buffer_load_dwordx4 v8, s[44:47], s40 offen lds
    s_add_u32 s41, s39, 1024
    s_mov_b32 m0, s41
    s_nop 0
    buffer_load_dwordx4 v9, s[44:47], s40 offen lds
    s_add_u32 s41, s39, 2048
    s_mov_b32 m0, s41
    s_nop 0
    buffer_load_dwordx4 v10, s[44:47], s40 offen lds
    s_cmp_ge_u32 s26, 4
    s_cbranch_scc1 KMB_dskip
    s_add_u32 s39, s26, 24
    s_mul_i32 s40, s39, 43008
    s_add_u32 s40, s40, s38
    s_mul_i32 s39, s39, 3072
    s_add_u32 s41, s39, 0
    s_mov_b32 m0, s41
    s_nop 0
    buffer_load_dwordx4 v8, s[44:47], s40 offen lds
    s_add_u32 s41, s39, 1024
    s_mov_b32 m0, s41
    s_nop 0
    buffer_load_dwordx4 v9, s[44:47], s40 offen lds
    s_add_u32 s41, s39, 2048
    s_mov_b32 m0, s41
    s_nop 0
    buffer_load_dwordx4 v10, s[44:47], s40 offen lds
KMB_dskip:
    s_lshl_b32 s34, s2, 3
    s_add_u32 s34, s34, s26
    s_min_u32 s34, s34, 1791
    v_lshrrev_b32 v4, 2, v1
    v_and_b32 v5, 3, v1
    s_mov_b32 s54, 0
    s_cmp_lt_u32 s34, 224
    s_cbranch_scc1 KM_sh_wo
    s_cmp_lt_u32 s34, 1008
    s_cbranch_scc1 KM_sh_w1
KM_sh_w2:
    s_sub_u32 s34, s34, 1008
    s_mov_b32 s35, 0x4924925
    s_mul_hi_u32 s38, s34, s35
    s_mul_i32 s39, s38, 56
    s_sub_u32 s39, s34, s39
    s_movk_i32 s40, 896
    v_mul_lo_u32 v6, v4, s40
    v_lshl_add_u32 v6, v5, 4, v6
    s_mul_i32 s40, s39, 28672
    s_lshl_b32 s41, s38, 6
    s_add_u32 s40, s40, s41
    s_lshl_b32 s41, s26, 11
    s_add_u32 s41, s41, 88064
    s_mov_b32 m0, s41
    s_mov_b32 s44, s74
    s_and_b32 s45, s75, 0xffff
    s_mov_b32 s46, 1605632
    s_mov_b32 s47, 0x00020000
    buffer_load_dwordx4 v6, s[44:47], s40 offen lds
    s_add_u32 s41, s41, 1024
    s_mov_b32 m0, s41
    s_add_u32 s40, s40, 14336
    buffer_load_dwordx4 v6, s[44:47], s40 offen lds
    s_mul_i32 s53, s38, 112
    s_lshl_b32 s41, s39, 1
    s_add_u32 s53, s53, s41
    s_lshl_b32 s53, s53, 10
    s_add_u32 s53, s53, 26214400
    s_branch KM_shg
KM_sh_wo:
    s_sub_u32 s34, s34, 0
    s_mov_b32 s35, 0x10000000
    s_mul_hi_u32 s38, s34, s35
    s_mul_i32 s39, s38, 16
    s_sub_u32 s39, s34, s39
    s_movk_i32 s40, 896
    v_mul_lo_u32 v6, v4, s40
    v_lshl_add_u32 v6, v5, 4, v6
    s_mov_b32 s54, 1
    s_mul_i32 s40, s39, 25088
    s_lshl_b32 s41, s38, 6
    s_add_u32 s40, s40, s41
    s_lshl_b32 s41, s26, 11
    s_add_u32 s41, s41, 88064
    s_mov_b32 m0, s41
    s_mov_b32 s44, s68
    s_and_b32 s45, s69, 0xffff
    s_mov_b32 s46, 401408
    s_mov_b32 s47, 0x00020000
    buffer_load_dwordx4 v6, s[44:47], s40 offen lds
    s_add_u32 s41, s41, 1024
    s_mov_b32 m0, s41
    s_add_u32 s40, s40, 14336
    buffer_load_dwordx4 v6, s[44:47], s40 offen lds
    s_mul_i32 s53, s38, 32
    s_lshl_b32 s41, s39, 1
    s_add_u32 s53, s53, s41
    s_lshl_b32 s53, s53, 10
    s_add_u32 s53, s53, 23068672
    s_branch KM_shg
KM_sh_w1:
    s_sub_u32 s34, s34, 224
    s_mov_b32 s35, 0x12492493
    s_mul_hi_u32 s38, s34, s35
    s_mul_i32 s39, s38, 14
    s_sub_u32 s39, s34, s39
    s_movk_i32 s40, 3584
    v_mul_lo_u32 v6, v4, s40
    v_lshl_add_u32 v6, v5, 4, v6
    s_mul_i32 s40, s39, 114688
    s_lshl_b32 s41, s38, 6
    s_add_u32 s40, s40, s41
    s_lshl_b32 s41, s26, 11
    s_add_u32 s41, s41, 88064
    s_mov_b32 m0, s41
    s_mov_b32 s44, s72
    s_and_b32 s45, s73, 0xffff
    s_mov_b32 s46, 1605632
    s_mov_b32 s47, 0x00020000
    buffer_load_dwordx4 v6, s[44:47], s40 offen lds
    s_add_u32 s41, s41, 1024
    s_mov_b32 m0, s41
    s_add_u32 s40, s40, 57344
    buffer_load_dwordx4 v6, s[44:47], s40 offen lds
    s_mul_i32 s53, s38, 28
    s_lshl_b32 s41, s39, 1
    s_add_u32 s53, s53, s41
    s_lshl_b32 s53, s53, 10
    s_add_u32 s53, s53, 24117248
    s_branch KM_shg
KM_shg:
    s_cmp_ge_u32 s2, 42
    s_cbranch_scc1 KM_nomod
    s_cmp_lt_u32 s26, 4
    s_cbranch_scc1 KM_mbar
    s_waitcnt vmcnt(25)
    s_mov_b32 s40, 0xbfb8aa3b
    v_lshlrev_b32 v80, 16, v80
    v_mul_f32 v76, s40, v80
    v_exp_f32 v76, v76
    s_nop 0
    v_add_f32 v76, 1.0, v76
    v_rcp_f32 v76, v76
    s_nop 0
    v_mul_f32 v80, v80, v76
    v_cvt_pk_bf16_f32 v80, v80, v80
    v_lshlrev_b32 v80, 16, v80
    v_lshlrev_b32 v81, 16, v81
    v_mul_f32 v76, s40, v81
    v_exp_f32 v76, v76
    s_nop 0
    v_add_f32 v76, 1.0, v76
    v_rcp_f32 v76, v76
    s_nop 0
    v_mul_f32 v81, v81, v76
    v_cvt_pk_bf16_f32 v81, v81, v81
    v_lshlrev_b32 v81, 16, v81
    v_lshlrev_b32 v82, 16, v82
    v_mul_f32 v76, s40, v82
    v_exp_f32 v76, v76
    s_nop 0
    v_add_f32 v76, 1.0, v76
    v_rcp_f32 v76, v76
    s_nop 0
    v_mul_f32 v82, v82, v76
    v_cvt_pk_bf16_f32 v82, v82, v82
    v_lshlrev_b32 v82, 16, v82
    v_lshlrev_b32 v83, 16, v83
    v_mul_f32 v76, s40, v83
    v_exp_f32 v76, v76
    s_nop 0
    v_add_f32 v76, 1.0, v76
    v_rcp_f32 v76, v76
    s_nop 0
    v_mul_f32 v83, v83, v76
    v_cvt_pk_bf16_f32 v83, v83, v83
    v_lshlrev_b32 v83, 16, v83
    v_lshlrev_b32 v84, 16, v84
    v_mul_f32 v76, s40, v84
    v_exp_f32 v76, v76
    s_nop 0
    v_add_f32 v76, 1.0, v76
    v_rcp_f32 v76, v76
    s_nop 0
    v_mul_f32 v84, v84, v76
    v_cvt_pk_bf16_f32 v84, v84, v84
    v_lshlrev_b32 v84, 16, v84
    v_lshlrev_b32 v85, 16, v85
    v_mul_f32 v76, s40, v85
    v_exp_f32 v76, v76
    s_nop 0
    v_add_f32 v76, 1.0, v76
    v_rcp_f32 v76, v76
    s_nop 0
    v_mul_f32 v85, v85, v76
    v_cvt_pk_bf16_f32 v85, v85, v85
    v_lshlrev_b32 v85, 16, v85
    v_lshlrev_b32 v86, 16, v86
    v_mul_f32 v76, s40, v86
    v_exp_f32 v76, v76
    s_nop 0
    v_add_f32 v76, 1.0, v76
    v_rcp_f32 v76, v76
    s_nop 0
    v_mul_f32 v86, v86, v76
    v_cvt_pk_bf16_f32 v86, v86, v86
    v_lshlrev_b32 v86, 16, v86
    v_lshlrev_b32 v87, 16, v87
    v_mul_f32 v76, s40, v87
    v_exp_f32 v76, v76
    s_nop 0
    v_add_f32 v76, 1.0, v76
    v_rcp_f32 v76, v76
    s_nop 0
    v_mul_f32 v87, v87, v76
    v_cvt_pk_bf16_f32 v87, v87, v87
    v_lshlrev_b32 v87, 16, v87
    v_lshlrev_b32 v88, 16, v88
    v_mul_f32 v76, s40, v88
    v_exp_f32 v76, v76
    s_nop 0
    v_add_f32 v76, 1.0, v76
    v_rcp_f32 v76, v76
    s_nop 0
    v_mul_f32 v88, v88, v76
    v_cvt_pk_bf16_f32 v88, v88, v88
    v_lshlrev_b32 v88, 16, v88
    v_lshlrev_b32 v89, 16, v89
    v_mul_f32 v76, s40, v89
    v_exp_f32 v76, v76
    s_nop 0
    v_add_f32 v76, 1.0, v76
    v_rcp_f32 v76, v76
    s_nop 0
    v_mul_f32 v89, v89, v76
    v_cvt_pk_bf16_f32 v89, v89, v89
    v_lshlrev_b32 v89, 16, v89
    v_lshlrev_b32 v90, 16, v90
    v_mul_f32 v76, s40, v90
    v_exp_f32 v76, v76
    s_nop 0
    v_add_f32 v76, 1.0, v76
    v_rcp_f32 v76, v76
    s_nop 0
    v_mul_f32 v90, v90, v76
    v_cvt_pk_bf16_f32 v90, v90, v90
    v_lshlrev_b32 v90, 16, v90
    v_lshlrev_b32 v91, 16, v91
    v_mul_f32 v76, s40, v91
    v_exp_f32 v76, v76
    s_nop 0
    v_add_f32 v76, 1.0, v76
    v_rcp_f32 v76, v76
    s_nop 0
    v_mul_f32 v91, v91, v76
    v_cvt_pk_bf16_f32 v91, v91, v91
    v_lshlrev_b32 v91, 16, v91
    v_lshlrev_b32 v92, 16, v92
    v_mul_f32 v76, s40, v92
    v_exp_f32 v76, v76
    s_nop 0
    v_add_f32 v76, 1.0, v76
    v_rcp_f32 v76, v76
    s_nop 0
    v_mul_f32 v92, v92, v76
    v_cvt_pk_bf16_f32 v92, v92, v92
    v_lshlrev_b32 v92, 16, v92
    v_lshlrev_b32 v93, 16, v93
    v_mul_f32 v76, s40, v93
    v_exp_f32 v76, v76
    s_nop 0
    v_add_f32 v76, 1.0, v76
    v_rcp_f32 v76, v76
    s_nop 0
    v_mul_f32 v93, v93, v76
    v_cvt_pk_bf16_f32 v93, v93, v93
    v_lshlrev_b32 v93, 16, v93
    v_mov_b32 v152, 0
    v_mov_b32 v153, 0
    v_mov_b32 v154, 0
    v_mov_b32 v155, 0
    v_mov_b32 v156, 0
    v_mov_b32 v157, 0
    v_mov_b32 v158, 0
    v_mov_b32 v159, 0
    s_waitcnt vmcnt(24)
    v_lshlrev_b32 v76, 16, v96
    v_and_b32 v77, 0xffff0000, v96
    v_fmac_f32 v152, v76, v80
    v_fmac_f32 v153, v77, v80
    v_lshlrev_b32 v76, 16, v97
    v_and_b32 v77, 0xffff0000, v97
    v_fmac_f32 v154, v76, v80
    v_fmac_f32 v155, v77, v80
    v_lshlrev_b32 v76, 16, v98
    v_and_b32 v77, 0xffff0000, v98
    v_fmac_f32 v156, v76, v80
    v_fmac_f32 v157, v77, v80
    v_lshlrev_b32 v76, 16, v99
    v_and_b32 v77, 0xffff0000, v99
    v_fmac_f32 v158, v76, v80
    v_fmac_f32 v159, v77, v80
    s_waitcnt vmcnt(23)
    v_lshlrev_b32 v76, 16, v100
    v_and_b32 v77, 0xffff0000, v100
    v_fmac_f32 v152, v76, v81
    v_fmac_f32 v153, v77, v81
    v_lshlrev_b32 v76, 16, v101
    v_and_b32 v77, 0xffff0000, v101
    v_fmac_f32 v154, v76, v81
    v_fmac_f32 v155, v77, v81
    v_lshlrev_b32 v76, 16, v102
    v_and_b32 v77, 0xffff0000, v102
    v_fmac_f32 v156, v76, v81
    v_fmac_f32 v157, v77, v81
    v_lshlrev_b32 v76, 16, v103
    v_and_b32 v77, 0xffff0000, v103
    v_fmac_f32 v158, v76, v81
    v_fmac_f32 v159, v77, v81
    s_waitcnt vmcnt(22)
    v_lshlrev_b32 v76, 16, v104
    v_and_b32 v77, 0xffff0000, v104
    v_fmac_f32 v152, v76, v82
    v_fmac_f32 v153, v77, v82
    v_lshlrev_b32 v76, 16, v105
    v_and_b32 v77, 0xffff0000, v105
    v_fmac_f32 v154, v76, v82
    v_fmac_f32 v155, v77, v82
    v_lshlrev_b32 v76, 16, v106
    v_and_b32 v77, 0xffff0000, v106
    v_fmac_f32 v156, v76, v82
    v_fmac_f32 v157, v77, v82
    v_lshlrev_b32 v76, 16, v107
    v_and_b32 v77, 0xffff0000, v107
    v_fmac_f32 v158, v76, v82
    v_fmac_f32 v159, v77, v82
    s_waitcnt vmcnt(21)
    v_lshlrev_b32 v76, 16, v108
    v_and_b32 v77, 0xffff0000, v108
    v_fmac_f32 v152, v76, v83
    v_fmac_f32 v153, v77, v83
    v_lshlrev_b32 v76, 16, v109
    v_and_b32 v77, 0xffff0000, v109
    v_fmac_f32 v154, v76, v83
    v_fmac_f32 v155, v77, v83
    v_lshlrev_b32 v76, 16, v110
    v_and_b32 v77, 0xffff0000, v110
    v_fmac_f32 v156, v76, v83
    v_fmac_f32 v157, v77, v83
    v_lshlrev_b32 v76, 16, v111
    v_and_b32 v77, 0xffff0000, v111
    v_fmac_f32 v158, v76, v83
    v_fmac_f32 v159, v77, v83
    s_waitcnt vmcnt(20)
    v_lshlrev_b32 v76, 16, v112
    v_and_b32 v77, 0xffff0000, v112
    v_fmac_f32 v152, v76, v84
    v_fmac_f32 v153, v77, v84
    v_lshlrev_b32 v76, 16, v113
    v_and_b32 v77, 0xffff0000, v113
    v_fmac_f32 v154, v76, v84
    v_fmac_f32 v155, v77, v84
    v_lshlrev_b32 v76, 16, v114
    v_and_b32 v77, 0xffff0000, v114
    v_fmac_f32 v156, v76, v84
    v_fmac_f32 v157, v77, v84
    v_lshlrev_b32 v76, 16, v115
    v_and_b32 v77, 0xffff0000, v115
    v_fmac_f32 v158, v76, v84
    v_fmac_f32 v159, v77, v84
    s_waitcnt vmcnt(19)
    v_lshlrev_b32 v76, 16, v116
    v_and_b32 v77, 0xffff0000, v116
    v_fmac_f32 v152, v76, v85
    v_fmac_f32 v153, v77, v85
    v_lshlrev_b32 v76, 16, v117
    v_and_b32 v77, 0xffff0000, v117
    v_fmac_f32 v154, v76, v85
    v_fmac_f32 v155, v77, v85
    v_lshlrev_b32 v76, 16, v118
    v_and_b32 v77, 0xffff0000, v118
    v_fmac_f32 v156, v76, v85
    v_fmac_f32 v157, v77, v85
    v_lshlrev_b32 v76, 16, v119
    v_and_b32 v77, 0xffff0000, v119
    v_fmac_f32 v158, v76, v85
    v_fmac_f32 v159, v77, v85
    s_waitcnt vmcnt(18)
    v_lshlrev_b32 v76, 16, v120
    v_and_b32 v77, 0xffff0000, v120
    v_fmac_f32 v152, v76, v86
    v_fmac_f32 v153, v77, v86
    v_lshlrev_b32 v76, 16, v121
    v_and_b32 v77, 0xffff0000, v121
    v_fmac_f32 v154, v76, v86
    v_fmac_f32 v155, v77, v86
    v_lshlrev_b32 v76, 16, v122
    v_and_b32 v77, 0xffff0000, v122
    v_fmac_f32 v156, v76, v86
    v_fmac_f32 v157, v77, v86
    v_lshlrev_b32 v76, 16, v123
    v_and_b32 v77, 0xffff0000, v123
    v_fmac_f32 v158, v76, v86
    v_fmac_f32 v159, v77, v86
    s_waitcnt vmcnt(17)
    v_lshlrev_b32 v76, 16, v124
    v_and_b32 v77, 0xffff0000, v124
    v_fmac_f32 v152, v76, v87
    v_fmac_f32 v153, v77, v87
    v_lshlrev_b32 v76, 16, v125
    v_and_b32 v77, 0xffff0000, v125
    v_fmac_f32 v154, v76, v87
    v_fmac_f32 v155, v77, v87
    v_lshlrev_b32 v76, 16, v126
    v_and_b32 v77, 0xffff0000, v126
    v_fmac_f32 v156, v76, v87
    v_fmac_f32 v157, v77, v87
    v_lshlrev_b32 v76, 16, v127
    v_and_b32 v77, 0xffff0000, v127
    v_fmac_f32 v158, v76, v87
    v_fmac_f32 v159, v77, v87
    s_waitcnt vmcnt(16)
    v_lshlrev_b32 v76, 16, v128
    v_and_b32 v77, 0xffff0000, v128
    v_fmac_f32 v152, v76, v88
    v_fmac_f32 v153, v77, v88
    v_lshlrev_b32 v76, 16, v129
    v_and_b32 v77, 0xffff0000, v129
    v_fmac_f32 v154, v76, v88
    v_fmac_f32 v155, v77, v88
    v_lshlrev_b32 v76, 16, v130
    v_and_b32 v77, 0xffff0000, v130
    v_fmac_f32 v156, v76, v88
    v_fmac_f32 v157, v77, v88
    v_lshlrev_b32 v76, 16, v131
    v_and_b32 v77, 0xffff0000, v131
    v_fmac_f32 v158, v76, v88
    v_fmac_f32 v159, v77, v88
    s_waitcnt vmcnt(15)
    v_lshlrev_b32 v76, 16, v132
    v_and_b32 v77, 0xffff0000, v132
    v_fmac_f32 v152, v76, v89
    v_fmac_f32 v153, v77, v89
    v_lshlrev_b32 v76, 16, v133
    v_and_b32 v77, 0xffff0000, v133
    v_fmac_f32 v154, v76, v89
    v_fmac_f32 v155, v77, v89
    v_lshlrev_b32 v76, 16, v134
    v_and_b32 v77, 0xffff0000, v134
    v_fmac_f32 v156, v76, v89
    v_fmac_f32 v157, v77, v89
    v_lshlrev_b32 v76, 16, v135
    v_and_b32 v77, 0xffff0000, v135
    v_fmac_f32 v158, v76, v89
    v_fmac_f32 v159, v77, v89
    s_waitcnt vmcnt(14)
    v_lshlrev_b32 v76, 16, v136
    v_and_b32 v77, 0xffff0000, v136
    v_fmac_f32 v152, v76, v90
    v_fmac_f32 v153, v77, v90
    v_lshlrev_b32 v76, 16, v137
    v_and_b32 v77, 0xffff0000, v137
    v_fmac_f32 v154, v76, v90
    v_fmac_f32 v155, v77, v90
    v_lshlrev_b32 v76, 16, v138
    v_and_b32 v77, 0xffff0000, v138
    v_fmac_f32 v156, v76, v90
    v_fmac_f32 v157, v77, v90
    v_lshlrev_b32 v76, 16, v139
    v_and_b32 v77, 0xffff0000, v139
    v_fmac_f32 v158, v76, v90
    v_fmac_f32 v159, v77, v90
    s_waitcnt vmcnt(13)
    v_lshlrev_b32 v76, 16, v140
    v_and_b32 v77, 0xffff0000, v140
    v_fmac_f32 v152, v76, v91
    v_fmac_f32 v153, v77, v91
    v_lshlrev_b32 v76, 16, v141
    v_and_b32 v77, 0xffff0000, v141
    v_fmac_f32 v154, v76, v91
    v_fmac_f32 v155, v77, v91
    v_lshlrev_b32 v76, 16, v142
    v_and_b32 v77, 0xffff0000, v142
    v_fmac_f32 v156, v76, v91
    v_fmac_f32 v157, v77, v91
    v_lshlrev_b32 v76, 16, v143
    v_and_b32 v77, 0xffff0000, v143
    v_fmac_f32 v158, v76, v91
    v_fmac_f32 v159, v77, v91
    s_waitcnt vmcnt(12)
    v_lshlrev_b32 v76, 16, v144
    v_and_b32 v77, 0xffff0000, v144
    v_fmac_f32 v152, v76, v92
    v_fmac_f32 v153, v77, v92
    v_lshlrev_b32 v76, 16, v145
    v_and_b32 v77, 0xffff0000, v145
    v_fmac_f32 v154, v76, v92
    v_fmac_f32 v155, v77, v92
    v_lshlrev_b32 v76, 16, v146
    v_and_b32 v77, 0xffff0000, v146
    v_fmac_f32 v156, v76, v92
    v_fmac_f32 v157, v77, v92
    v_lshlrev_b32 v76, 16, v147
    v_and_b32 v77, 0xffff0000, v147
    v_fmac_f32 v158, v76, v92
    v_fmac_f32 v159, v77, v92
    s_waitcnt vmcnt(11)
    v_lshlrev_b32 v76, 16, v148
    v_and_b32 v77, 0xffff0000, v148
    v_fmac_f32 v152, v76, v93
    v_fmac_f32 v153, v77, v93
    v_lshlrev_b32 v76, 16, v149
    v_and_b32 v77, 0xffff0000, v149
    v_fmac_f32 v154, v76, v93
    v_fmac_f32 v155, v77, v93
    v_lshlrev_b32 v76, 16, v150
    v_and_b32 v77, 0xffff0000, v150
    v_fmac_f32 v156, v76, v93
    v_fmac_f32 v157, v77, v93
    v_lshlrev_b32 v76, 16, v151
    v_and_b32 v77, 0xffff0000, v151
    v_fmac_f32 v158, v76, v93
    v_fmac_f32 v159, v77, v93
    v_lshlrev_b32 v76, 8, v73
    v_lshl_add_u32 v76, v72, 5, v76
    v_add_u32 v76, 118272, v76
    ds_write_b128 v76, v[152:155]
    ds_write_b128 v76, v[156:159] offset:16
    s_waitcnt lgkmcnt(0)
KM_mbar:
    s_barrier
    s_cmp_lg_u32 s26, 3
    s_cbranch_scc1 KM_nomod
    v_lshlrev_b32 v76, 2, v1
    v_add_u32 v77, 118272, v76
    ds_read_b32 v96, v77 offset:0
    ds_read_b32 v97, v77 offset:256
    ds_read_b32 v98, v77 offset:512
    ds_read_b32 v99, v77 offset:768
    ds_read_b32 v100, v77 offset:1024
    ds_read_b32 v101, v77 offset:1280
    ds_read_b32 v102, v77 offset:1536
    ds_read_b32 v103, v77 offset:1792
    ds_read_b32 v104, v77 offset:2048
    ds_read_b32 v105, v77 offset:2304
    ds_read_b32 v106, v77 offset:2560
    ds_read_b32 v107, v77 offset:2816
    ds_read_b32 v108, v77 offset:3072
    ds_read_b32 v109, v77 offset:3328
    ds_read_b32 v110, v77 offset:3584
    ds_read_b32 v111, v77 offset:3840
    ds_read_b32 v112, v77 offset:4096
    ds_read_b32 v113, v77 offset:4352
    ds_read_b32 v114, v77 offset:4608
    ds_read_b32 v115, v77 offset:4864
    ds_read_b32 v116, v77 offset:5120
    ds_read_b32 v117, v77 offset:5376
    ds_read_b32 v118, v77 offset:5632
    ds_read_b32 v119, v77 offset:5888
    ds_read_b32 v120, v77 offset:6144
    ds_read_b32 v121, v77 offset:6400
    ds_read_b32 v122, v77 offset:6656
    ds_read_b32 v123, v77 offset:6912
    ds_read_b32 v124, v77 offset:7168
    ds_read_b32 v125, v77 offset:7424
    ds_read_b32 v126, v77 offset:7680
    ds_read_b32 v127, v77 offset:7936
    s_waitcnt lgkmcnt(0)
    v_add_f32 v96, v96, v112
    v_add_f32 v97, v97, v113
    v_add_f32 v98, v98, v114
    v_add_f32 v99, v99, v115
    v_add_f32 v100, v100, v116
    v_add_f32 v101, v101, v117
    v_add_f32 v102, v102, v118
    v_add_f32 v103, v103, v119
    v_add_f32 v104, v104, v120
    v_add_f32 v105, v105, v121
    v_add_f32 v106, v106, v122
    v_add_f32 v107, v107, v123
    v_add_f32 v108, v108, v124
    v_add_f32 v109, v109, v125
    v_add_f32 v110, v110, v126
    v_add_f32 v111, v111, v127
    v_add_f32 v96, v96, v104
    v_add_f32 v97, v97, v105
    v_add_f32 v98, v98, v106
    v_add_f32 v99, v99, v107
    v_add_f32 v100, v100, v108
    v_add_f32 v101, v101, v109
    v_add_f32 v102, v102, v110
    v_add_f32 v103, v103, v111
    v_add_f32 v96, v96, v100
    v_add_f32 v97, v97, v101
    v_add_f32 v98, v98, v102
    v_add_f32 v99, v99, v103
    v_add_f32 v96, v96, v98
    v_add_f32 v97, v97, v99
    v_add_f32 v96, v96, v97
    v_cvt_pk_bf16_f32 v96, v96, v96
    v_lshlrev_b32 v96, 16, v96
    s_lshl_b32 s41, s2, 8
    buffer_store_dword v96, v76, s[8:11], s41 offen offset:0 sc1
    v_mov_b32 v3, 0
    s_mov_b32 s40, 0
INI2_loop:
    buffer_load_dword v4, v3, s[20:23], 0 offen sc1
    s_waitcnt vmcnt(0)
    v_readfirstlane_b32 s44, v4
    s_add_u32 s40, s40, 1
    s_cmp_ge_u32 s40, 0x40000
    s_cbranch_scc1 INI2_done
    s_cmp_eq_u32 s44, 1
    s_cbranch_scc1 INI2_done
    s_sleep 8
    s_branch INI2_loop
INI2_done:
    s_mov_b64 s[42:43], exec
    s_mov_b64 exec, 0xff
    v_lshlrev_b32 v3, 9, v1
    v_mov_b32 v4, 1
    s_mov_b32 s41, 32538624
    buffer_atomic_add v4, v3, s[8:11], s41 offen
    s_mov_b64 exec, s[42:43]
KM_nomod:
    v_accvgpr_write_b32 a0, 0
    v_accvgpr_write_b32 a1, 0
    v_accvgpr_write_b32 a2, 0
    v_accvgpr_write_b32 a3, 0
    v_accvgpr_write_b32 a4, 0
    v_accvgpr_write_b32 a5, 0
    v_accvgpr_write_b32 a6, 0
    v_accvgpr_write_b32 a7, 0
    v_accvgpr_write_b32 a8, 0
    v_accvgpr_write_b32 a9, 0
    v_accvgpr_write_b32 a10, 0
    v_accvgpr_write_b32 a11, 0
    v_accvgpr_write_b32 a12, 0
    v_accvgpr_write_b32 a13, 0
    v_accvgpr_write_b32 a14, 0
    v_accvgpr_write_b32 a15, 0
    v_accvgpr_write_b32 a16, 0
    v_accvgpr_write_b32 a17, 0
    v_accvgpr_write_b32 a18, 0
    v_accvgpr_write_b32 a19, 0
    v_accvgpr_write_b32 a20, 0
    v_accvgpr_write_b32 a21, 0
    v_accvgpr_write_b32 a22, 0
    v_accvgpr_write_b32 a23, 0
    v_accvgpr_write_b32 a24, 0
    v_accvgpr_write_b32 a25, 0
    v_accvgpr_write_b32 a26, 0
    v_accvgpr_write_b32 a27, 0
    v_accvgpr_write_b32 a28, 0
    v_accvgpr_write_b32 a29, 0
    v_accvgpr_write_b32 a30, 0
    v_accvgpr_write_b32 a31, 0
    v_accvgpr_write_b32 a32, 0
    v_accvgpr_write_b32 a33, 0
    v_accvgpr_write_b32 a34, 0
    v_accvgpr_write_b32 a35, 0
    v_accvgpr_write_b32 a36, 0
    v_accvgpr_write_b32 a37, 0
    v_accvgpr_write_b32 a38, 0
    v_accvgpr_write_b32 a39, 0
    v_accvgpr_write_b32 a40, 0
    v_accvgpr_write_b32 a41, 0
    v_accvgpr_write_b32 a42, 0
    v_accvgpr_write_b32 a43, 0
    v_accvgpr_write_b32 a44, 0
    v_accvgpr_write_b32 a45, 0
    v_accvgpr_write_b32 a46, 0
    v_accvgpr_write_b32 a47, 0
    s_cmp_lg_u32 s26, 0
    s_cbranch_scc1 KM_ci0
    v_mov_b32 v3, 0
    s_mov_b32 s40, 0
INI3_loop:
    buffer_load_dword v4, v3, s[20:23], 0 offen sc1
    s_waitcnt vmcnt(0)
    v_readfirstlane_b32 s44, v4
    s_add_u32 s40, s40, 1
    s_cmp_ge_u32 s40, 0x40000
    s_cbranch_scc1 INI3_done
    s_cmp_eq_u32 s44, 1
    s_cbranch_scc1 INI3_done
    s_sleep 8
    s_branch INI3_loop
INI3_done:
KM_ci0:
    s_cmp_lg_u32 s26, 0
    s_cbranch_scc1 WL4_bar
    s_mov_b64 s[42:43], exec
    s_mov_b64 exec, 1
    v_mov_b32 v3, 0
    s_lshl_b32 s41, s24, 9
    s_add_u32 s41, s41, 32546816
    s_mov_b32 s40, 0
    v_mov_b32 v5, 16
WL4_loop:
    buffer_load_dword v4, v3, s[8:11], s41 offen sc1
    s_waitcnt vmcnt(0)
    v_cmp_lt_u32 vcc, v4, v5
    s_add_u32 s40, s40, 1
    s_cmp_ge_u32 s40, 0x40000
    s_cbranch_scc1 WL4_done
    s_nop 2
    s_cbranch_vccz WL4_done
    s_sleep 2
    s_branch WL4_loop
WL4_done:
    s_mov_b64 exec, s[42:43]
WL4_bar:
    s_barrier
    s_and_b32 s34, s26, 3
    s_lshr_b32 s35, s26, 2
    s_lshl_b32 s52, s24, 2
    s_add_u32 s52, s52, s34
    s_mul_i32 s37, s52, 28672
    s_mul_i32 s38, s35, 14336
    s_add_u32 s37, s37, s38
    s_add_u32 s37, s37, 65536
    s_add_u32 s39, s37, 0
    buffer_load_dwordx4 v[16:19], v2, s[8:11], s39 offen offset:0
    buffer_load_dwordx4 v[20:23], v2, s[8:11], s39 offen offset:1024
    buffer_load_dwordx4 v[24:27], v2, s[8:11], s39 offen offset:2048
    buffer_load_dwordx4 v[28:31], v2, s[8:11], s39 offen offset:3072
    s_add_u32 s39, s37, 4096
    buffer_load_dwordx4 v[32:35], v2, s[8:11], s39 offen offset:0
    buffer_load_dwordx4 v[36:39], v2, s[8:11], s39 offen offset:1024
    buffer_load_dwordx4 v[40:43], v2, s[8:11], s39 offen offset:2048
    buffer_load_dwordx4 v[44:47], v2, s[8:11], s39 offen offset:3072
    s_add_u32 s39, s37, 8192
    buffer_load_dwordx4 v[48:51], v2, s[8:11], s39 offen offset:0
    buffer_load_dwordx4 v[52:55], v2, s[8:11], s39 offen offset:1024
    buffer_load_dwordx4 v[56:59], v2, s[8:11], s39 offen offset:2048
    buffer_load_dwordx4 v[60:63], v2, s[8:11], s39 offen offset:3072
    s_add_u32 s39, s37, 12288
    buffer_load_dwordx4 v[64:67], v2, s[8:11], s39 offen offset:0
    buffer_load_dwordx4 v[68:71], v2, s[8:11], s39 offen offset:1024
    v_lshrrev_b32 v4, 5, v1
    v_lshlrev_b32 v4, 2, v4
    v_bfe_u32 v5, v1, 2, 2
    v_add_u32 v4, v4, v5
    v_lshlrev_b32 v4, 6, v4
    v_bfe_u32 v5, v1, 4, 1
    v_lshl_add_u32 v4, v5, 5, v4
    v_and_b32 v5, 3, v1
    v_lshl_add_u32 v4, v5, 3, v4
    s_lshl_b32 s41, s26, 11
    s_add_u32 s41, s41, 88064
    v_add_u32 v4, s41, v4
    v_cmp_gt_u32 vcc, 32, v1
    s_waitcnt vmcnt(14)
    ds_read_b64_tr_b16 v[180:181], v4 offset:0
    ds_read_b64_tr_b16 v[182:183], v4 offset:512
    ds_read_b64_tr_b16 v[184:185], v4 offset:1024
    ds_read_b64_tr_b16 v[186:187], v4 offset:1536
    s_waitcnt lgkmcnt(0)
    s_cmp_eq_u32 s54, 0
    s_cbranch_scc1 KM_shnz
    v_cndmask_b32 v186, 0, v186, vcc
    v_cndmask_b32 v187, 0, v187, vcc
KM_shnz:
    buffer_store_dwordx4 v[180:183], v2, s[8:11], s53 offen offset:0 sc1
    buffer_store_dwordx4 v[184:187], v2, s[8:11], s53 offen offset:1024 sc1
    s_and_b32 s45, s2, 7
    s_cmp_lg_u32 s26, 0
    s_cbranch_scc1 WL5_bar
    s_mov_b64 s[42:43], exec
    s_mov_b64 exec, 1
    v_mov_b32 v3, 0
    s_lshl_b32 s41, s45, 9
    s_add_u32 s41, s41, 32538624
    s_mov_b32 s40, 0
    v_mov_b32 v5, 42
WL5_loop:
    buffer_load_dword v4, v3, s[8:11], s41 offen sc1
    s_waitcnt vmcnt(0)
    v_cmp_lt_u32 vcc, v4, v5
    s_add_u32 s40, s40, 1
    s_cmp_ge_u32 s40, 0x40000
    s_cbranch_scc1 WL5_done
    s_nop 2
    s_cbranch_vccz WL5_done
    s_sleep 2
    s_branch WL5_loop
WL5_done:
    s_mov_b64 exec, s[42:43]
WL5_bar:
    s_barrier
    v_cmp_gt_u32 vcc, 112, v0
    v_subrev_u32 v4, 112, v0
    s_nop 0
    v_cndmask_b32 v4, v4, v0, vcc
    v_mov_b32 v5, 0
    v_mov_b32 v6, 1792
    v_cndmask_b32 v5, v5, v6, vcc
    v_lshl_add_u32 v5, v4, 4, v5
    s_movk_i32 s46, 224
    v_cmp_gt_u32 s[60:61], s46, v0
    v_mov_b32 v6, 0x7f000000
    s_nop 0
    v_cndmask_b32 v5, v6, v5, s[60:61]
    buffer_load_dwordx4 v[8:11], v5, s[8:11], 0 offen
    v_lshlrev_b32 v6, 4, v4
    v_mov_b32 v7, 116480
    v_mov_b32 v12, 114688
    v_cndmask_b32 v7, v7, v12, vcc
    v_add_u32 v13, v6, v7
    v_lshrrev_b32 v4, 5, v1
    v_lshlrev_b32 v4, 5, v4
    s_mul_i32 s39, s35, 896
    s_add_u32 s39, s39, 114688
    v_add_u32 v4, s39, v4
    v_lshrrev_b32 v5, 5, v1
    v_lshlrev_b32 v5, 3, v5
    v_bfe_u32 v6, v1, 2, 2
    v_add_u32 v5, v5, v6
    v_mul_u32_u24 v5, 192, v5
    v_bfe_u32 v6, v1, 4, 1
    v_lshl_add_u32 v5, v6, 5, v5
    v_and_b32 v6, 3, v1
    v_lshl_add_u32 v5, v6, 3, v5
    s_mul_i32 s39, s35, 43008
    v_add_u32 v5, s39, v5
    s_waitcnt vmcnt(0)
    v_add_f32 v12, 1.0, v8
    v_cvt_pk_bf16_f32 v12, v12, v12
    v_lshlrev_b32 v12, 16, v12
    v_cndmask_b32 v8, v8, v12, vcc
    v_add_f32 v12, 1.0, v9
    v_cvt_pk_bf16_f32 v12, v12, v12
    v_lshlrev_b32 v12, 16, v12
    v_cndmask_b32 v9, v9, v12, vcc
    v_add_f32 v12, 1.0, v10
    v_cvt_pk_bf16_f32 v12, v12, v12
    v_lshlrev_b32 v12, 16, v12
    v_cndmask_b32 v10, v10, v12, vcc
    v_add_f32 v12, 1.0, v11
    v_cvt_pk_bf16_f32 v12, v12, v12
    v_lshlrev_b32 v12, 16, v12
    v_cndmask_b32 v11, v11, v12, vcc
    s_and_saveexec_b64 s[46:47], s[60:61]
    ds_write_b128 v13, v[8:11]
    s_mov_b64 exec, s[46:47]
    s_waitcnt lgkmcnt(0)
    s_barrier
    ds_read_b128 v[104:107], v4 offset:0
    ds_read_b128 v[108:111], v4 offset:16
    ds_read_b128 v[112:115], v4 offset:1792
    ds_read_b128 v[116:119], v4 offset:1808
    ds_read_b128 v[120:123], v4 offset:64
    ds_read_b128 v[124:127], v4 offset:80
    ds_read_b128 v[128:131], v4 offset:1856
    ds_read_b128 v[132:135], v4 offset:1872
    ds_read_b64_tr_b16 v[72:73], v5 offset:0
    ds_read_b64_tr_b16 v[74:75], v5 offset:768
    ds_read_b64_tr_b16 v[76:77], v5 offset:56
    ds_read_b64_tr_b16 v[78:79], v5 offset:824
    ds_read_b64_tr_b16 v[80:81], v5 offset:112
    ds_read_b64_tr_b16 v[82:83], v5 offset:880
    s_waitcnt lgkmcnt(0)
    v_lshlrev_b32 v144, 16, v16
    v_and_b32 v145, 0xffff0000, v16
    v_fma_f32 v144, v144, v104, v112
    v_fma_f32 v145, v145, v105, v113
    v_cvt_pk_bf16_f32 v136, v144, v145
    v_lshlrev_b32 v146, 16, v17
    v_and_b32 v147, 0xffff0000, v17
    v_fma_f32 v146, v146, v106, v114
    v_fma_f32 v147, v147, v107, v115
    v_cvt_pk_bf16_f32 v137, v146, v147
    v_lshlrev_b32 v148, 16, v18
    v_and_b32 v149, 0xffff0000, v18
    v_fma_f32 v148, v148, v108, v116
    v_fma_f32 v149, v149, v109, v117
    v_cvt_pk_bf16_f32 v138, v148, v149
    v_lshlrev_b32 v150, 16, v19
    v_and_b32 v151, 0xffff0000, v19
    v_fma_f32 v150, v150, v110, v118
    v_fma_f32 v151, v151, v111, v119
    v_cvt_pk_bf16_f32 v139, v150, v151
    ds_read_b128 v[104:107], v4 offset:128
    ds_read_b128 v[108:111], v4 offset:144
    ds_read_b128 v[112:115], v4 offset:1920
    ds_read_b128 v[116:119], v4 offset:1936
    ds_read_b64_tr_b16 v[84:85], v5 offset:3072
    ds_read_b64_tr_b16 v[86:87], v5 offset:3840
    ds_read_b64_tr_b16 v[88:89], v5 offset:3128
    ds_read_b64_tr_b16 v[90:91], v5 offset:3896
    ds_read_b64_tr_b16 v[92:93], v5 offset:3184
    ds_read_b64_tr_b16 v[94:95], v5 offset:3952
    s_nop 1
    v_mfma_f32_32x32x16_bf16 a[0:15], v[72:75], v[136:139], a[0:15]
    v_lshlrev_b32 v144, 16, v20
    v_and_b32 v145, 0xffff0000, v20
    v_fma_f32 v144, v144, v120, v128
    v_fma_f32 v145, v145, v121, v129
    v_cvt_pk_bf16_f32 v140, v144, v145
    v_lshlrev_b32 v146, 16, v21
    v_and_b32 v147, 0xffff0000, v21
    v_mfma_f32_32x32x16_bf16 a[16:31], v[76:79], v[136:139], a[16:31]
    v_fma_f32 v146, v146, v122, v130
    v_fma_f32 v147, v147, v123, v131
    v_cvt_pk_bf16_f32 v141, v146, v147
    v_lshlrev_b32 v148, 16, v22
    v_and_b32 v149, 0xffff0000, v22
    v_fma_f32 v148, v148, v124, v132
    v_fma_f32 v149, v149, v125, v133
    v_mfma_f32_32x32x16_bf16 a[32:47], v[80:83], v[136:139], a[32:47]
    v_cvt_pk_bf16_f32 v142, v148, v149
    v_lshlrev_b32 v150, 16, v23
    v_and_b32 v151, 0xffff0000, v23
    v_fma_f32 v150, v150, v126, v134
    v_fma_f32 v151, v151, v127, v135
    v_cvt_pk_bf16_f32 v143, v150, v151
    s_waitcnt lgkmcnt(0)
    ds_read_b128 v[120:123], v4 offset:192
    ds_read_b128 v[124:127], v4 offset:208
    ds_read_b128 v[128:131], v4 offset:1984
    ds_read_b128 v[132:135], v4 offset:2000
    ds_read_b64_tr_b16 v[72:73], v5 offset:6144
    ds_read_b64_tr_b16 v[74:75], v5 offset:6912
    ds_read_b64_tr_b16 v[76:77], v5 offset:6200
    ds_read_b64_tr_b16 v[78:79], v5 offset:6968
    ds_read_b64_tr_b16 v[80:81], v5 offset:6256
    ds_read_b64_tr_b16 v[82:83], v5 offset:7024
    s_nop 1
    v_mfma_f32_32x32x16_bf16 a[0:15], v[84:87], v[140:143], a[0:15]
    v_lshlrev_b32 v144, 16, v24
    v_and_b32 v145, 0xffff0000, v24
    v_fma_f32 v144, v144, v104, v112
    v_fma_f32 v145, v145, v105, v113
    v_cvt_pk_bf16_f32 v136, v144, v145
    v_lshlrev_b32 v146, 16, v25
    v_and_b32 v147, 0xffff0000, v25
    v_mfma_f32_32x32x16_bf16 a[16:31], v[88:91], v[140:143], a[16:31]
    v_fma_f32 v146, v146, v106, v114
    v_fma_f32 v147, v147, v107, v115
    v_cvt_pk_bf16_f32 v137, v146, v147
    v_lshlrev_b32 v148, 16, v26
    v_and_b32 v149, 0xffff0000, v26
    v_fma_f32 v148, v148, v108, v116
    v_fma_f32 v149, v149, v109, v117
    v_mfma_f32_32x32x16_bf16 a[32:47], v[92:95], v[140:143], a[32:47]
    v_cvt_pk_bf16_f32 v138, v148, v149
    v_lshlrev_b32 v150, 16, v27
    v_and_b32 v151, 0xffff0000, v27
    v_fma_f32 v150, v150, v110, v118
    v_fma_f32 v151, v151, v111, v119
    v_cvt_pk_bf16_f32 v139, v150, v151
    s_waitcnt lgkmcnt(0)
    ds_read_b128 v[104:107], v4 offset:256
    ds_read_b128 v[108:111], v4 offset:272
    ds_read_b128 v[112:115], v4 offset:2048
    ds_read_b128 v[116:119], v4 offset:2064
    ds_read_b64_tr_b16 v[84:85], v5 offset:9216
    ds_read_b64_tr_b16 v[86:87], v5 offset:9984
    ds_read_b64_tr_b16 v[88:89], v5 offset:9272
    ds_read_b64_tr_b16 v[90:91], v5 offset:10040
    ds_read_b64_tr_b16 v[92:93], v5 offset:9328
    ds_read_b64_tr_b16 v[94:95], v5 offset:10096
    s_nop 1
    v_mfma_f32_32x32x16_bf16 a[0:15], v[72:75], v[136:139], a[0:15]
    v_lshlrev_b32 v144, 16, v28
    v_and_b32 v145, 0xffff0000, v28
    v_fma_f32 v144, v144, v120, v128
    v_fma_f32 v145, v145, v121, v129
    v_cvt_pk_bf16_f32 v140, v144, v145
    v_lshlrev_b32 v146, 16, v29
    v_and_b32 v147, 0xffff0000, v29
    v_mfma_f32_32x32x16_bf16 a[16:31], v[76:79], v[136:139], a[16:31]
    v_fma_f32 v146, v146, v122, v130
    v_fma_f32 v147, v147, v123, v131
    v_cvt_pk_bf16_f32 v141, v146, v147
    v_lshlrev_b32 v148, 16, v30
    v_and_b32 v149, 0xffff0000, v30
    v_fma_f32 v148, v148, v124, v132
    v_fma_f32 v149, v149, v125, v133
    v_mfma_f32_32x32x16_bf16 a[32:47], v[80:83], v[136:139], a[32:47]
    v_cvt_pk_bf16_f32 v142, v148, v149
    v_lshlrev_b32 v150, 16, v31
    v_and_b32 v151, 0xffff0000, v31
    v_fma_f32 v150, v150, v126, v134
    v_fma_f32 v151, v151, v127, v135
    v_cvt_pk_bf16_f32 v143, v150, v151
    s_waitcnt lgkmcnt(0)
    ds_read_b128 v[120:123], v4 offset:320
    ds_read_b128 v[124:127], v4 offset:336
    ds_read_b128 v[128:131], v4 offset:2112
    ds_read_b128 v[132:135], v4 offset:2128
    ds_read_b64_tr_b16 v[72:73], v5 offset:12288
    ds_read_b64_tr_b16 v[74:75], v5 offset:13056
    ds_read_b64_tr_b16 v[76:77], v5 offset:12344
    ds_read_b64_tr_b16 v[78:79], v5 offset:13112
    ds_read_b64_tr_b16 v[80:81], v5 offset:12400
    ds_read_b64_tr_b16 v[82:83], v5 offset:13168
    s_nop 1
    v_mfma_f32_32x32x16_bf16 a[0:15], v[84:87], v[140:143], a[0:15]
    v_lshlrev_b32 v144, 16, v32
    v_and_b32 v145, 0xffff0000, v32
    v_fma_f32 v144, v144, v104, v112
    v_fma_f32 v145, v145, v105, v113
    v_cvt_pk_bf16_f32 v136, v144, v145
    v_lshlrev_b32 v146, 16, v33
    v_and_b32 v147, 0xffff0000, v33
    v_mfma_f32_32x32x16_bf16 a[16:31], v[88:91], v[140:143], a[16:31]
    v_fma_f32 v146, v146, v106, v114
    v_fma_f32 v147, v147, v107, v115
    v_cvt_pk_bf16_f32 v137, v146, v147
    v_lshlrev_b32 v148, 16, v34
    v_and_b32 v149, 0xffff0000, v34
    v_fma_f32 v148, v148, v108, v116
    v_fma_f32 v149, v149, v109, v117
    v_mfma_f32_32x32x16_bf16 a[32:47], v[92:95], v[140:143], a[32:47]
    v_cvt_pk_bf16_f32 v138, v148, v149
    v_lshlrev_b32 v150, 16, v35
    v_and_b32 v151, 0xffff0000, v35
    v_fma_f32 v150, v150, v110, v118
    v_fma_f32 v151, v151, v111, v119
    v_cvt_pk_bf16_f32 v139, v150, v151
    s_waitcnt lgkmcnt(0)
    ds_read_b128 v[104:107], v4 offset:384
    ds_read_b128 v[108:111], v4 offset:400
    ds_read_b128 v[112:115], v4 offset:2176
    ds_read_b128 v[116:119], v4 offset:2192
    ds_read_b64_tr_b16 v[84:85], v5 offset:15360
    ds_read_b64_tr_b16 v[86:87], v5 offset:16128
    ds_read_b64_tr_b16 v[88:89], v5 offset:15416
    ds_read_b64_tr_b16 v[90:91], v5 offset:16184
    ds_read_b64_tr_b16 v[92:93], v5 offset:15472
    ds_read_b64_tr_b16 v[94:95], v5 offset:16240
    s_nop 1
    v_mfma_f32_32x32x16_bf16 a[0:15], v[72:75], v[136:139], a[0:15]
    v_lshlrev_b32 v144, 16, v36
    v_and_b32 v145, 0xffff0000, v36
    v_fma_f32 v144, v144, v120, v128
    v_fma_f32 v145, v145, v121, v129
    v_cvt_pk_bf16_f32 v140, v144, v145
    v_lshlrev_b32 v146, 16, v37
    v_and_b32 v147, 0xffff0000, v37
    v_mfma_f32_32x32x16_bf16 a[16:31], v[76:79], v[136:139], a[16:31]
    v_fma_f32 v146, v146, v122, v130
    v_fma_f32 v147, v147, v123, v131
    v_cvt_pk_bf16_f32 v141, v146, v147
    v_lshlrev_b32 v148, 16, v38
    v_and_b32 v149, 0xffff0000, v38
    v_fma_f32 v148, v148, v124, v132
    v_fma_f32 v149, v149, v125, v133
    v_mfma_f32_32x32x16_bf16 a[32:47], v[80:83], v[136:139], a[32:47]
    v_cvt_pk_bf16_f32 v142, v148, v149
    v_lshlrev_b32 v150, 16, v39
    v_and_b32 v151, 0xffff0000, v39
    v_fma_f32 v150, v150, v126, v134
    v_fma_f32 v151, v151, v127, v135
    v_cvt_pk_bf16_f32 v143, v150, v151
    s_waitcnt lgkmcnt(0)
    ds_read_b128 v[120:123], v4 offset:448
    ds_read_b128 v[124:127], v4 offset:464
    ds_read_b128 v[128:131], v4 offset:2240
    ds_read_b128 v[132:135], v4 offset:2256
    ds_read_b64_tr_b16 v[72:73], v5 offset:18432
    ds_read_b64_tr_b16 v[74:75], v5 offset:19200
    ds_read_b64_tr_b16 v[76:77], v5 offset:18488
    ds_read_b64_tr_b16 v[78:79], v5 offset:19256
    ds_read_b64_tr_b16 v[80:81], v5 offset:18544
    ds_read_b64_tr_b16 v[82:83], v5 offset:19312
    s_nop 1
    v_mfma_f32_32x32x16_bf16 a[0:15], v[84:87], v[140:143], a[0:15]
    v_lshlrev_b32 v144, 16, v40
    v_and_b32 v145, 0xffff0000, v40
    v_fma_f32 v144, v144, v104, v112
    v_fma_f32 v145, v145, v105, v113
    v_cvt_pk_bf16_f32 v136, v144, v145
    v_lshlrev_b32 v146, 16, v41
    v_and_b32 v147, 0xffff0000, v41
    v_mfma_f32_32x32x16_bf16 a[16:31], v[88:91], v[140:143], a[16:31]
    v_fma_f32 v146, v146, v106, v114
    v_fma_f32 v147, v147, v107, v115
    v_cvt_pk_bf16_f32 v137, v146, v147
    v_lshlrev_b32 v148, 16, v42
    v_and_b32 v149, 0xffff0000, v42
    v_fma_f32 v148, v148, v108, v116
    v_fma_f32 v149, v149, v109, v117
    v_mfma_f32_32x32x16_bf16 a[32:47], v[92:95], v[140:143], a[32:47]
    v_cvt_pk_bf16_f32 v138, v148, v149
    v_lshlrev_b32 v150, 16, v43
    v_and_b32 v151, 0xffff0000, v43
    v_fma_f32 v150, v150, v110, v118
    v_fma_f32 v151, v151, v111, v119
    v_cvt_pk_bf16_f32 v139, v150, v151
    s_waitcnt lgkmcnt(0)
    ds_read_b128 v[104:107], v4 offset:512
    ds_read_b128 v[108:111], v4 offset:528
    ds_read_b128 v[112:115], v4 offset:2304
    ds_read_b128 v[116:119], v4 offset:2320
    ds_read_b64_tr_b16 v[84:85], v5 offset:21504
    ds_read_b64_tr_b16 v[86:87], v5 offset:22272
    ds_read_b64_tr_b16 v[88:89], v5 offset:21560
    ds_read_b64_tr_b16 v[90:91], v5 offset:22328
    ds_read_b64_tr_b16 v[92:93], v5 offset:21616
    ds_read_b64_tr_b16 v[94:95], v5 offset:22384
    s_nop 1
    v_mfma_f32_32x32x16_bf16 a[0:15], v[72:75], v[136:139], a[0:15]
    v_lshlrev_b32 v144, 16, v44
    v_and_b32 v145, 0xffff0000, v44
    v_fma_f32 v144, v144, v120, v128
    v_fma_f32 v145, v145, v121, v129
    v_cvt_pk_bf16_f32 v140, v144, v145
    v_lshlrev_b32 v146, 16, v45
    v_and_b32 v147, 0xffff0000, v45
    v_mfma_f32_32x32x16_bf16 a[16:31], v[76:79], v[136:139], a[16:31]
    v_fma_f32 v146, v146, v122, v130
    v_fma_f32 v147, v147, v123, v131
    v_cvt_pk_bf16_f32 v141, v146, v147
    v_lshlrev_b32 v148, 16, v46
    v_and_b32 v149, 0xffff0000, v46
    v_fma_f32 v148, v148, v124, v132
    v_fma_f32 v149, v149, v125, v133
    v_mfma_f32_32x32x16_bf16 a[32:47], v[80:83], v[136:139], a[32:47]
    v_cvt_pk_bf16_f32 v142, v148, v149
    v_lshlrev_b32 v150, 16, v47
    v_and_b32 v151, 0xffff0000, v47
    v_fma_f32 v150, v150, v126, v134
    v_fma_f32 v151, v151, v127, v135
    v_cvt_pk_bf16_f32 v143, v150, v151
    s_waitcnt lgkmcnt(0)
    ds_read_b128 v[120:123], v4 offset:576
    ds_read_b128 v[124:127], v4 offset:592
    ds_read_b128 v[128:131], v4 offset:2368
    ds_read_b128 v[132:135], v4 offset:2384
    ds_read_b64_tr_b16 v[72:73], v5 offset:24576
    ds_read_b64_tr_b16 v[74:75], v5 offset:25344
    ds_read_b64_tr_b16 v[76:77], v5 offset:24632
    ds_read_b64_tr_b16 v[78:79], v5 offset:25400
    ds_read_b64_tr_b16 v[80:81], v5 offset:24688
    ds_read_b64_tr_b16 v[82:83], v5 offset:25456
    s_nop 1
    v_mfma_f32_32x32x16_bf16 a[0:15], v[84:87], v[140:143], a[0:15]
    v_lshlrev_b32 v144, 16, v48
    v_and_b32 v145, 0xffff0000, v48
    v_fma_f32 v144, v144, v104, v112
    v_fma_f32 v145, v145, v105, v113
    v_cvt_pk_bf16_f32 v136, v144, v145
    v_lshlrev_b32 v146, 16, v49
    v_and_b32 v147, 0xffff0000, v49
    v_mfma_f32_32x32x16_bf16 a[16:31], v[88:91], v[140:143], a[16:31]
    v_fma_f32 v146, v146, v106, v114
    v_fma_f32 v147, v147, v107, v115
    v_cvt_pk_bf16_f32 v137, v146, v147
    v_lshlrev_b32 v148, 16, v50
    v_and_b32 v149, 0xffff0000, v50
    v_fma_f32 v148, v148, v108, v116
    v_fma_f32 v149, v149, v109, v117
    v_mfma_f32_32x32x16_bf16 a[32:47], v[92:95], v[140:143], a[32:47]
    v_cvt_pk_bf16_f32 v138, v148, v149
    v_lshlrev_b32 v150, 16, v51
    v_and_b32 v151, 0xffff0000, v51
    v_fma_f32 v150, v150, v110, v118
    v_fma_f32 v151, v151, v111, v119
    v_cvt_pk_bf16_f32 v139, v150, v151
    s_waitcnt lgkmcnt(0)
    ds_read_b128 v[104:107], v4 offset:640
    ds_read_b128 v[108:111], v4 offset:656
    ds_read_b128 v[112:115], v4 offset:2432
    ds_read_b128 v[116:119], v4 offset:2448
    ds_read_b64_tr_b16 v[84:85], v5 offset:27648
    ds_read_b64_tr_b16 v[86:87], v5 offset:28416
    ds_read_b64_tr_b16 v[88:89], v5 offset:27704
    ds_read_b64_tr_b16 v[90:91], v5 offset:28472
    ds_read_b64_tr_b16 v[92:93], v5 offset:27760
    ds_read_b64_tr_b16 v[94:95], v5 offset:28528
    s_nop 1
    v_mfma_f32_32x32x16_bf16 a[0:15], v[72:75], v[136:139], a[0:15]
    v_lshlrev_b32 v144, 16, v52
    v_and_b32 v145, 0xffff0000, v52
    v_fma_f32 v144, v144, v120, v128
    v_fma_f32 v145, v145, v121, v129
    v_cvt_pk_bf16_f32 v140, v144, v145
    v_lshlrev_b32 v146, 16, v53
    v_and_b32 v147, 0xffff0000, v53
    v_mfma_f32_32x32x16_bf16 a[16:31], v[76:79], v[136:139], a[16:31]
    v_fma_f32 v146, v146, v122, v130
    v_fma_f32 v147, v147, v123, v131
    v_cvt_pk_bf16_f32 v141, v146, v147
    v_lshlrev_b32 v148, 16, v54
    v_and_b32 v149, 0xffff0000, v54
    v_fma_f32 v148, v148, v124, v132
    v_fma_f32 v149, v149, v125, v133
    v_mfma_f32_32x32x16_bf16 a[32:47], v[80:83], v[136:139], a[32:47]
    v_cvt_pk_bf16_f32 v142, v148, v149
    v_lshlrev_b32 v150, 16, v55
    v_and_b32 v151, 0xffff0000, v55
    v_fma_f32 v150, v150, v126, v134
    v_fma_f32 v151, v151, v127, v135
    v_cvt_pk_bf16_f32 v143, v150, v151
    s_waitcnt lgkmcnt(0)
    ds_read_b128 v[120:123], v4 offset:704
    ds_read_b128 v[124:127], v4 offset:720
    ds_read_b128 v[128:131], v4 offset:2496
    ds_read_b128 v[132:135], v4 offset:2512
    ds_read_b64_tr_b16 v[72:73], v5 offset:30720
    ds_read_b64_tr_b16 v[74:75], v5 offset:31488
    ds_read_b64_tr_b16 v[76:77], v5 offset:30776
    ds_read_b64_tr_b16 v[78:79], v5 offset:31544
    ds_read_b64_tr_b16 v[80:81], v5 offset:30832
    ds_read_b64_tr_b16 v[82:83], v5 offset:31600
    s_nop 1
    v_mfma_f32_32x32x16_bf16 a[0:15], v[84:87], v[140:143], a[0:15]
    v_lshlrev_b32 v144, 16, v56
    v_and_b32 v145, 0xffff0000, v56
    v_fma_f32 v144, v144, v104, v112
    v_fma_f32 v145, v145, v105, v113
    v_cvt_pk_bf16_f32 v136, v144, v145
    v_lshlrev_b32 v146, 16, v57
    v_and_b32 v147, 0xffff0000, v57
    v_mfma_f32_32x32x16_bf16 a[16:31], v[88:91], v[140:143], a[16:31]
    v_fma_f32 v146, v146, v106, v114
    v_fma_f32 v147, v147, v107, v115
    v_cvt_pk_bf16_f32 v137, v146, v147
    v_lshlrev_b32 v148, 16, v58
    v_and_b32 v149, 0xffff0000, v58
    v_fma_f32 v148, v148, v108, v116
    v_fma_f32 v149, v149, v109, v117
    v_mfma_f32_32x32x16_bf16 a[32:47], v[92:95], v[140:143], a[32:47]
    v_cvt_pk_bf16_f32 v138, v148, v149
    v_lshlrev_b32 v150, 16, v59
    v_and_b32 v151, 0xffff0000, v59
    v_fma_f32 v150, v150, v110, v118
    v_fma_f32 v151, v151, v111, v119
    v_cvt_pk_bf16_f32 v139, v150, v151
    s_waitcnt lgkmcnt(0)
    ds_read_b128 v[104:107], v4 offset:768
    ds_read_b128 v[108:111], v4 offset:784
    ds_read_b128 v[112:115], v4 offset:2560
    ds_read_b128 v[116:119], v4 offset:2576
    ds_read_b64_tr_b16 v[84:85], v5 offset:33792
    ds_read_b64_tr_b16 v[86:87], v5 offset:34560
    ds_read_b64_tr_b16 v[88:89], v5 offset:33848
    ds_read_b64_tr_b16 v[90:91], v5 offset:34616
    ds_read_b64_tr_b16 v[92:93], v5 offset:33904
    ds_read_b64_tr_b16 v[94:95], v5 offset:34672
    s_nop 1
    v_mfma_f32_32x32x16_bf16 a[0:15], v[72:75], v[136:139], a[0:15]
    v_lshlrev_b32 v144, 16, v60
    v_and_b32 v145, 0xffff0000, v60
    v_fma_f32 v144, v144, v120, v128
    v_fma_f32 v145, v145, v121, v129
    v_cvt_pk_bf16_f32 v140, v144, v145
    v_lshlrev_b32 v146, 16, v61
    v_and_b32 v147, 0xffff0000, v61
    v_mfma_f32_32x32x16_bf16 a[16:31], v[76:79], v[136:139], a[16:31]
    v_fma_f32 v146, v146, v122, v130
    v_fma_f32 v147, v147, v123, v131
    v_cvt_pk_bf16_f32 v141, v146, v147
    v_lshlrev_b32 v148, 16, v62
    v_and_b32 v149, 0xffff0000, v62
    v_fma_f32 v148, v148, v124, v132
    v_fma_f32 v149, v149, v125, v133
    v_mfma_f32_32x32x16_bf16 a[32:47], v[80:83], v[136:139], a[32:47]
    v_cvt_pk_bf16_f32 v142, v148, v149
    v_lshlrev_b32 v150, 16, v63
    v_and_b32 v151, 0xffff0000, v63
    v_fma_f32 v150, v150, v126, v134
    v_fma_f32 v151, v151, v127, v135
    v_cvt_pk_bf16_f32 v143, v150, v151
    s_waitcnt lgkmcnt(0)
    ds_read_b128 v[120:123], v4 offset:832
    ds_read_b128 v[124:127], v4 offset:848
    ds_read_b128 v[128:131], v4 offset:2624
    ds_read_b128 v[132:135], v4 offset:2640
    ds_read_b64_tr_b16 v[72:73], v5 offset:36864
    ds_read_b64_tr_b16 v[74:75], v5 offset:37632
    ds_read_b64_tr_b16 v[76:77], v5 offset:36920
    ds_read_b64_tr_b16 v[78:79], v5 offset:37688
    ds_read_b64_tr_b16 v[80:81], v5 offset:36976
    ds_read_b64_tr_b16 v[82:83], v5 offset:37744
    s_nop 1
    v_mfma_f32_32x32x16_bf16 a[0:15], v[84:87], v[140:143], a[0:15]
    v_lshlrev_b32 v144, 16, v64
    v_and_b32 v145, 0xffff0000, v64
    v_fma_f32 v144, v144, v104, v112
    v_fma_f32 v145, v145, v105, v113
    v_cvt_pk_bf16_f32 v136, v144, v145
    v_lshlrev_b32 v146, 16, v65
    v_and_b32 v147, 0xffff0000, v65
    v_mfma_f32_32x32x16_bf16 a[16:31], v[88:91], v[140:143], a[16:31]
    v_fma_f32 v146, v146, v106, v114
    v_fma_f32 v147, v147, v107, v115
    v_cvt_pk_bf16_f32 v137, v146, v147
    v_lshlrev_b32 v148, 16, v66
    v_and_b32 v149, 0xffff0000, v66
    v_fma_f32 v148, v148, v108, v116
    v_fma_f32 v149, v149, v109, v117
    v_mfma_f32_32x32x16_bf16 a[32:47], v[92:95], v[140:143], a[32:47]
    v_cvt_pk_bf16_f32 v138, v148, v149
    v_lshlrev_b32 v150, 16, v67
    v_and_b32 v151, 0xffff0000, v67
    v_fma_f32 v150, v150, v110, v118
    v_fma_f32 v151, v151, v111, v119
    v_cvt_pk_bf16_f32 v139, v150, v151
    s_waitcnt lgkmcnt(0)
    ds_read_b64_tr_b16 v[84:85], v5 offset:39936
    ds_read_b64_tr_b16 v[86:87], v5 offset:40704
    ds_read_b64_tr_b16 v[88:89], v5 offset:39992
    ds_read_b64_tr_b16 v[90:91], v5 offset:40760
    ds_read_b64_tr_b16 v[92:93], v5 offset:40048
    ds_read_b64_tr_b16 v[94:95], v5 offset:40816
    s_nop 1
    v_mfma_f32_32x32x16_bf16 a[0:15], v[72:75], v[136:139], a[0:15]
    v_lshlrev_b32 v144, 16, v68
    v_and_b32 v145, 0xffff0000, v68
    v_fma_f32 v144, v144, v120, v128
    v_fma_f32 v145, v145, v121, v129
    v_cvt_pk_bf16_f32 v140, v144, v145
    v_lshlrev_b32 v146, 16, v69
    v_and_b32 v147, 0xffff0000, v69
    v_mfma_f32_32x32x16_bf16 a[16:31], v[76:79], v[136:139], a[16:31]
    v_fma_f32 v146, v146, v122, v130
    v_fma_f32 v147, v147, v123, v131
    v_cvt_pk_bf16_f32 v141, v146, v147
    v_lshlrev_b32 v148, 16, v70
    v_and_b32 v149, 0xffff0000, v70
    v_fma_f32 v148, v148, v124, v132
    v_fma_f32 v149, v149, v125, v133
    v_mfma_f32_32x32x16_bf16 a[32:47], v[80:83], v[136:139], a[32:47]
    v_cvt_pk_bf16_f32 v142, v148, v149
    v_lshlrev_b32 v150, 16, v71
    v_and_b32 v151, 0xffff0000, v71
    v_fma_f32 v150, v150, v126, v134
    v_fma_f32 v151, v151, v127, v135
    v_cvt_pk_bf16_f32 v143, v150, v151
    s_waitcnt lgkmcnt(0)
    s_nop 1
    v_mfma_f32_32x32x16_bf16 a[0:15], v[84:87], v[140:143], a[0:15]
    v_mfma_f32_32x32x16_bf16 a[16:31], v[88:91], v[140:143], a[16:31]
    v_mfma_f32_32x32x16_bf16 a[32:47], v[92:95], v[140:143], a[32:47]
    s_waitcnt lgkmcnt(0)
    s_barrier
    s_nop 7
    s_nop 3
    s_lshl_b32 s39, s34, 14
    v_add_u32 v7, s39, v2
    s_cmp_eq_u32 s35, 0
    s_cbranch_scc1 KMB_w0
    ds_write_b128 v7, a[0:3] offset:0
    ds_write_b128 v7, a[4:7] offset:1024
    ds_write_b128 v7, a[8:11] offset:2048
    ds_write_b128 v7, a[12:15] offset:3072
    ds_write_b128 v7, a[16:19] offset:4096
    ds_write_b128 v7, a[20:23] offset:5120
    ds_write_b128 v7, a[24:27] offset:6144
    ds_write_b128 v7, a[28:31] offset:7168
    s_branch KMB_w1
KMB_w0:
    ds_write_b128 v7, a[32:35] offset:8192
    ds_write_b128 v7, a[36:39] offset:9216
    ds_write_b128 v7, a[40:43] offset:10240
    ds_write_b128 v7, a[44:47] offset:11264
KMB_w1:
    s_waitcnt lgkmcnt(0)
    s_barrier
    v_and_b32 v6, 31, v1
    v_lshrrev_b32 v8, 3, v6
    v_lshlrev_b32 v8, 4, v8
    v_and_b32 v6, 7, v6
    v_add_u32 v6, v6, v8
    v_lshrrev_b32 v8, 5, v1
    v_lshl_add_u32 v6, v8, 3, v6
    v_lshlrev_b32 v6, 4, v6
    s_mul_i32 s37, s25, 393216
    s_lshl_b32 s38, s52, 11
    s_add_u32 s37, s37, s38
    s_add_u32 s37, s37, 2097152
    v_cmp_gt_u32 s[46:47], 32, v1
    s_cmp_eq_u32 s35, 0
    s_cbranch_scc0 KMB_f1
    ds_read_b128 v[16:19], v7 offset:0
    ds_read_b128 v[20:23], v7 offset:1024
    ds_read_b128 v[24:27], v7 offset:2048
    ds_read_b128 v[28:31], v7 offset:3072
    ds_read_b128 v[32:35], v7 offset:4096
    ds_read_b128 v[36:39], v7 offset:5120
    ds_read_b128 v[40:43], v7 offset:6144
    ds_read_b128 v[44:47], v7 offset:7168
    v_accvgpr_read_b32 v64, a0
    v_accvgpr_read_b32 v65, a1
    v_accvgpr_read_b32 v66, a2
    v_accvgpr_read_b32 v67, a3
    v_accvgpr_read_b32 v68, a4
    v_accvgpr_read_b32 v69, a5
    v_accvgpr_read_b32 v70, a6
    v_accvgpr_read_b32 v71, a7
    v_accvgpr_read_b32 v72, a8
    v_accvgpr_read_b32 v73, a9
    v_accvgpr_read_b32 v74, a10
    v_accvgpr_read_b32 v75, a11
    v_accvgpr_read_b32 v76, a12
    v_accvgpr_read_b32 v77, a13
    v_accvgpr_read_b32 v78, a14
    v_accvgpr_read_b32 v79, a15
    v_accvgpr_read_b32 v80, a16
    v_accvgpr_read_b32 v81, a17
    v_accvgpr_read_b32 v82, a18
    v_accvgpr_read_b32 v83, a19
    v_accvgpr_read_b32 v84, a20
    v_accvgpr_read_b32 v85, a21
    v_accvgpr_read_b32 v86, a22
    v_accvgpr_read_b32 v87, a23
    v_accvgpr_read_b32 v88, a24
    v_accvgpr_read_b32 v89, a25
    v_accvgpr_read_b32 v90, a26
    v_accvgpr_read_b32 v91, a27
    v_accvgpr_read_b32 v92, a28
    v_accvgpr_read_b32 v93, a29
    v_accvgpr_read_b32 v94, a30
    v_accvgpr_read_b32 v95, a31
    s_waitcnt lgkmcnt(0)
    v_add_f32 v64, v64, v16
    v_add_f32 v65, v65, v17
    v_add_f32 v66, v66, v18
    v_add_f32 v67, v67, v19
    v_add_f32 v68, v68, v20
    v_add_f32 v69, v69, v21
    v_add_f32 v70, v70, v22
    v_add_f32 v71, v71, v23
    v_add_f32 v72, v72, v24
    v_add_f32 v73, v73, v25
    v_add_f32 v74, v74, v26
    v_add_f32 v75, v75, v27
    v_add_f32 v76, v76, v28
    v_add_f32 v77, v77, v29
    v_add_f32 v78, v78, v30
    v_add_f32 v79, v79, v31
    v_cvt_pk_bf16_f32 v96, v64, v65
    v_cvt_pk_bf16_f32 v97, v66, v67
    v_cvt_pk_bf16_f32 v98, v68, v69
    v_cvt_pk_bf16_f32 v99, v70, v71
    v_cvt_pk_bf16_f32 v100, v72, v73
    v_cvt_pk_bf16_f32 v101, v74, v75
    v_cvt_pk_bf16_f32 v102, v76, v77
    v_cvt_pk_bf16_f32 v103, v78, v79
    v_cndmask_b32 v102, 0, v102, s[46:47]
    v_cndmask_b32 v103, 0, v103, s[46:47]
    s_add_u32 s38, s37, 0
    buffer_store_dwordx4 v[96:99], v6, s[8:11], s38 offen sc1
    buffer_store_dwordx4 v[100:103], v6, s[8:11], s38 offen offset:1024 sc1
    v_add_f32 v80, v80, v32
    v_add_f32 v81, v81, v33
    v_add_f32 v82, v82, v34
    v_add_f32 v83, v83, v35
    v_add_f32 v84, v84, v36
    v_add_f32 v85, v85, v37
    v_add_f32 v86, v86, v38
    v_add_f32 v87, v87, v39
    v_add_f32 v88, v88, v40
    v_add_f32 v89, v89, v41
    v_add_f32 v90, v90, v42
    v_add_f32 v91, v91, v43
    v_add_f32 v92, v92, v44
    v_add_f32 v93, v93, v45
    v_add_f32 v94, v94, v46
    v_add_f32 v95, v95, v47
    v_cvt_pk_bf16_f32 v104, v80, v81
    v_cvt_pk_bf16_f32 v105, v82, v83
    v_cvt_pk_bf16_f32 v106, v84, v85
    v_cvt_pk_bf16_f32 v107, v86, v87
    v_cvt_pk_bf16_f32 v108, v88, v89
    v_cvt_pk_bf16_f32 v109, v90, v91
    v_cvt_pk_bf16_f32 v110, v92, v93
    v_cvt_pk_bf16_f32 v111, v94, v95
    v_cndmask_b32 v110, 0, v110, s[46:47]
    v_cndmask_b32 v111, 0, v111, s[46:47]
    s_add_u32 s38, s37, 131072
    buffer_store_dwordx4 v[104:107], v6, s[8:11], s38 offen sc1
    buffer_store_dwordx4 v[108:111], v6, s[8:11], s38 offen offset:1024 sc1
    s_branch KMB_f2
KMB_f1:
    ds_read_b128 v[16:19], v7 offset:8192
    ds_read_b128 v[20:23], v7 offset:9216
    ds_read_b128 v[24:27], v7 offset:10240
    ds_read_b128 v[28:31], v7 offset:11264
    v_accvgpr_read_b32 v64, a32
    v_accvgpr_read_b32 v65, a33
    v_accvgpr_read_b32 v66, a34
    v_accvgpr_read_b32 v67, a35
    v_accvgpr_read_b32 v68, a36
    v_accvgpr_read_b32 v69, a37
    v_accvgpr_read_b32 v70, a38
    v_accvgpr_read_b32 v71, a39
    v_accvgpr_read_b32 v72, a40
    v_accvgpr_read_b32 v73, a41
    v_accvgpr_read_b32 v74, a42
    v_accvgpr_read_b32 v75, a43
    v_accvgpr_read_b32 v76, a44
    v_accvgpr_read_b32 v77, a45
    v_accvgpr_read_b32 v78, a46
    v_accvgpr_read_b32 v79, a47
    s_waitcnt lgkmcnt(0)
    v_add_f32 v64, v64, v16
    v_add_f32 v65, v65, v17
    v_add_f32 v66, v66, v18
    v_add_f32 v67, v67, v19
    v_add_f32 v68, v68, v20
    v_add_f32 v69, v69, v21
    v_add_f32 v70, v70, v22
    v_add_f32 v71, v71, v23
    v_add_f32 v72, v72, v24
    v_add_f32 v73, v73, v25
    v_add_f32 v74, v74, v26
    v_add_f32 v75, v75, v27
    v_add_f32 v76, v76, v28
    v_add_f32 v77, v77, v29
    v_add_f32 v78, v78, v30
    v_add_f32 v79, v79, v31
    v_cvt_pk_bf16_f32 v96, v64, v65
    v_cvt_pk_bf16_f32 v97, v66, v67
    v_cvt_pk_bf16_f32 v98, v68, v69
    v_cvt_pk_bf16_f32 v99, v70, v71
    v_cvt_pk_bf16_f32 v100, v72, v73
    v_cvt_pk_bf16_f32 v101, v74, v75
    v_cvt_pk_bf16_f32 v102, v76, v77
    v_cvt_pk_bf16_f32 v103, v78, v79
    v_cndmask_b32 v102, 0, v102, s[46:47]
    v_cndmask_b32 v103, 0, v103, s[46:47]
    s_add_u32 s38, s37, 262144
    buffer_store_dwordx4 v[96:99], v6, s[8:11], s38 offen sc1
    buffer_store_dwordx4 v[100:103], v6, s[8:11], s38 offen offset:1024 sc1
KMB_f2:
    s_waitcnt vmcnt(0)
    s_barrier
    s_cmp_lg_u32 s26, 0
    s_cbranch_scc1 KM_sigb
    s_mov_b64 s[40:41], exec
    s_mov_b64 exec, 1
    v_mov_b32 v3, 0
    v_mov_b32 v4, 1
    s_lshl_b32 s42, s24, 4
    s_add_u32 s42, s42, s25
    s_lshl_b32 s42, s42, 9
    s_add_u32 s42, s42, 32571392
    buffer_store_dword v4, v3, s[8:11], s42 offen sc1
    s_mov_b64 exec, s[40:41]
KM_sigb:
    s_waitcnt vmcnt(0)
    s_cmp_lg_u32 s26, 0
    s_cbranch_scc1 WB_bar
    s_mov_b64 s[42:43], exec
    s_mov_b64 exec, 0x1ff
    v_mul_u32_u24 v3, 43, v1
    v_lshrrev_b32 v3, 7, v3
    v_mul_u32_u24 v4, 3, v3
    v_sub_u32 v4, v1, v4
    v_sub_u32 v3, s24, v3
    v_max_i32 v3, 0, v3
    v_lshlrev_b32 v4, 4, v4
    v_add_u32 v4, s25, v4
    v_mul_u32_u24 v4, 43, v4
    v_lshrrev_b32 v4, 7, v4
    v_lshl_add_u32 v3, v3, 4, v4
    v_lshlrev_b32 v3, 9, v3
    s_mov_b32 s41, 32571392
    s_mov_b32 s40, 0
WB_loop:
    buffer_load_dword v4, v3, s[8:11], s41 offen sc1
    s_waitcnt vmcnt(0)
    v_cmp_ne_u32 vcc, 1, v4
    s_add_u32 s40, s40, 1
    s_cmp_ge_u32 s40, 0x40000
    s_cbranch_scc1 WB_done
    s_nop 2
    s_cbranch_vccz WB_done
    s_sleep 2
    s_branch WB_loop
WB_done:
    s_mov_b64 exec, s[42:43]
WB_bar:
    s_barrier
    s_cmp_lg_u32 s26, 0
    s_cbranch_scc1 KM_shsig
    s_mov_b64 s[40:41], exec
    s_mov_b64 exec, 1
    v_mov_b32 v3, 0
    v_mov_b32 v4, 1
    s_and_b32 s42, s2, 7
    s_lshl_b32 s42, s42, 9
    s_add_u32 s42, s42, 32542720
    buffer_atomic_add v4, v3, s[8:11], s42 offen
    s_mov_b64 exec, s[40:41]
KM_shsig:
    s_lshl_b32 s34, s25, 17
    s_lshl_b32 s35, s24, 13
    s_add_u32 s34, s34, s35
    s_add_u32 s34, s34, 4177920
    s_mul_i32 s35, s26, 3072
    s_add_u32 s36, s34, s35
    s_lshl_b32 s37, s24, 3
    s_sub_i32 s37, 16, s37
    s_max_i32 s37, s37, 0
    s_mul_i32 s38, s26, 3
    s_add_u32 s39, s38, 0
    s_cmp_lt_u32 s39, s37
    s_cbranch_scc1 KMC_sk0
    s_add_u32 s39, s35, 0
    s_mov_b32 m0, s39
    s_add_u32 s39, s36, 0
    buffer_load_dwordx4 v2, s[8:11], s39 offen lds
    s_add_u32 s39, s35, 24576
    s_mov_b32 m0, s39
    s_add_u32 s39, s36, 2097152
    buffer_load_dwordx4 v2, s[8:11], s39 offen lds
KMC_sk0:
    s_add_u32 s39, s38, 1
    s_cmp_lt_u32 s39, s37
    s_cbranch_scc1 KMC_sk1
    s_add_u32 s39, s35, 1024
    s_mov_b32 m0, s39
    s_add_u32 s39, s36, 1024
    buffer_load_dwordx4 v2, s[8:11], s39 offen lds
    s_add_u32 s39, s35, 25600
    s_mov_b32 m0, s39
    s_add_u32 s39, s36, 2098176
    buffer_load_dwordx4 v2, s[8:11], s39 offen lds
KMC_sk1:
    s_add_u32 s39, s38, 2
    s_cmp_lt_u32 s39, s37
    s_cbranch_scc1 KMC_sk2
    s_add_u32 s39, s35, 2048
    s_mov_b32 m0, s39
    s_add_u32 s39, s36, 2048
    buffer_load_dwordx4 v2, s[8:11], s39 offen lds
    s_add_u32 s39, s35, 26624
    s_mov_b32 m0, s39
    s_add_u32 s39, s36, 2099200
    buffer_load_dwordx4 v2, s[8:11], s39 offen lds
KMC_sk2:
    v_and_b32 v4, 15, v1
    v_lshrrev_b32 v5, 4, v1
    v_lshrrev_b32 v6, 1, v5
    v_lshlrev_b32 v6, 10, v6
    v_bfe_u32 v7, v4, 3, 1
    v_lshl_add_u32 v6, v7, 8, v6
    v_and_b32 v7, 1, v5
    v_lshl_add_u32 v6, v7, 7, v6
    v_and_b32 v7, 7, v1
    v_lshl_add_u32 v6, v7, 4, v6
    s_lshr_b32 s34, s26, 1
    s_lshl_b32 s35, s24, 2
    s_add_u32 s34, s34, s35
    s_lshl_b32 s35, s34, 11
    s_and_b32 s36, s26, 1
    s_lshl_b32 s36, s36, 9
    s_add_u32 s35, s35, s36
    s_lshl_b32 s36, s25, 17
    s_add_u32 s35, s35, s36
    s_add_u32 s35, s35, 2097152
    buffer_load_dwordx4 v[8:11], v6, s[8:11], s35 offen
    s_lshr_b32 s37, s26, 1
    s_lshl_b32 s37, s37, 11
    s_and_b32 s38, s26, 1
    s_lshl_b32 s38, s38, 9
    s_add_u32 s37, s37, s38
    s_add_u32 s39, s26, 1
    s_lshr_b32 s38, s39, 1
    s_lshl_b32 s38, s38, 11
    s_and_b32 s39, s39, 1
    s_lshl_b32 s39, s39, 9
    s_add_u32 s38, s38, s39
    v_add_u32 v12, s37, v6
    v_add_u32 v13, s38, v6
    v_lshrrev_b32 v7, 1, v5
    v_lshlrev_b32 v14, 8, v7
    v_and_b32 v7, 1, v1
    v_lshl_add_u32 v14, v7, 7, v14
    v_and_b32 v7, 1, v5
    v_lshl_add_u32 v14, v7, 6, v14
    v_bfe_u32 v7, v1, 2, 2
    v_lshl_add_u32 v14, v7, 4, v14
    v_bfe_u32 v7, v1, 1, 1
    v_lshl_add_u32 v14, v7, 3, v14
    v_add_u32 v15, s38, v14
    v_add_u32 v14, s37, v14
    v_lshlrev_b32 v7, 2, v5
    v_add_u32 v16, 0, v7
    v_cmp_gt_u32 s[48:49], v16, v4
    v_add_u32 v16, 1, v7
    v_cmp_gt_u32 s[50:51], v16, v4
    v_add_u32 v16, 2, v7
    v_cmp_gt_u32 s[52:53], v16, v4
    v_add_u32 v16, 3, v7
    v_cmp_gt_u32 s[54:55], v16, v4
    s_lshl_b32 s40, s24, 3
    s_add_u32 s40, s40, s26
    s_sub_i32 s40, 16, s40
    s_max_i32 s40, s40, 0
    s_waitcnt vmcnt(0)
    s_barrier
    ds_read_b128 v[100:103], v12 offset:0
    ds_read_b128 v[104:107], v13 offset:0
    ds_read_b128 v[108:111], v12 offset:2048
    ds_read_b128 v[112:115], v13 offset:2048
    s_waitcnt lgkmcnt(3)
    v_mfma_f32_16x16x32_bf16 v[32:35], v[100:103], v[8:11], 0
    ds_read_b128 v[100:103], v12 offset:4096
    s_waitcnt lgkmcnt(3)
    v_mfma_f32_16x16x32_bf16 v[36:39], v[104:107], v[8:11], 0
    ds_read_b128 v[104:107], v13 offset:4096
    s_waitcnt lgkmcnt(3)
    v_mfma_f32_16x16x32_bf16 v[40:43], v[108:111], v[8:11], 0
    ds_read_b128 v[108:111], v12 offset:6144
    s_waitcnt lgkmcnt(3)
    v_mfma_f32_16x16x32_bf16 v[44:47], v[112:115], v[8:11], 0
    ds_read_b128 v[112:115], v13 offset:6144
    s_waitcnt lgkmcnt(3)
    v_mfma_f32_16x16x32_bf16 v[48:51], v[100:103], v[8:11], 0
    ds_read_b128 v[100:103], v12 offset:8192
    s_waitcnt lgkmcnt(3)
    v_mfma_f32_16x16x32_bf16 v[52:55], v[104:107], v[8:11], 0
    ds_read_b128 v[104:107], v13 offset:8192
    s_waitcnt lgkmcnt(3)
    v_mfma_f32_16x16x32_bf16 v[56:59], v[108:111], v[8:11], 0
    ds_read_b128 v[108:111], v12 offset:10240
    s_waitcnt lgkmcnt(3)
    v_mfma_f32_16x16x32_bf16 v[60:63], v[112:115], v[8:11], 0
    ds_read_b128 v[112:115], v13 offset:10240
    s_waitcnt lgkmcnt(3)
    v_mfma_f32_16x16x32_bf16 v[64:67], v[100:103], v[8:11], 0
    ds_read_b128 v[100:103], v12 offset:12288
    s_waitcnt lgkmcnt(3)
    v_mfma_f32_16x16x32_bf16 v[68:71], v[104:107], v[8:11], 0
    ds_read_b128 v[104:107], v13 offset:12288
    s_waitcnt lgkmcnt(3)
    v_mfma_f32_16x16x32_bf16 v[72:75], v[108:111], v[8:11], 0
    ds_read_b128 v[108:111], v12 offset:14336
    s_waitcnt lgkmcnt(3)
    v_mfma_f32_16x16x32_bf16 v[76:79], v[112:115], v[8:11], 0
    ds_read_b128 v[112:115], v13 offset:14336
    s_waitcnt lgkmcnt(3)
    v_mfma_f32_16x16x32_bf16 v[80:83], v[100:103], v[8:11], 0
    ds_read_b128 v[100:103], v12 offset:16384
    s_waitcnt lgkmcnt(3)
    v_mfma_f32_16x16x32_bf16 v[84:87], v[104:107], v[8:11], 0
    s_waitcnt lgkmcnt(2)
    v_mfma_f32_16x16x32_bf16 v[88:91], v[108:111], v[8:11], 0
    s_waitcnt lgkmcnt(1)
    v_mfma_f32_16x16x32_bf16 v[92:95], v[112:115], v[8:11], 0
    s_waitcnt lgkmcnt(0)
    v_mfma_f32_16x16x32_bf16 v[96:99], v[100:103], v[8:11], 0
    s_nop 7
    v_mov_b32 v16, 0xf149f2ca
    v_cndmask_b32 v32, v16, v32, s[48:49]
    v_cndmask_b32 v96, v96, v16, s[48:49]
    v_cndmask_b32 v33, v16, v33, s[50:51]
    v_cndmask_b32 v97, v97, v16, s[50:51]
    v_cndmask_b32 v34, v16, v34, s[52:53]
    v_cndmask_b32 v98, v98, v16, s[52:53]
    v_cndmask_b32 v35, v16, v35, s[54:55]
    v_cndmask_b32 v99, v99, v16, s[54:55]
    s_cmp_le_u32 s40, 0
    s_cbranch_scc1 KMC_noskip
    v_mov_b32 v32, v16
    v_mov_b32 v33, v16
    v_mov_b32 v34, v16
    v_mov_b32 v35, v16
    s_cmp_le_u32 s40, 1
    s_cbranch_scc1 KMC_noskip
    v_mov_b32 v36, v16
    v_mov_b32 v37, v16
    v_mov_b32 v38, v16
    v_mov_b32 v39, v16
    s_cmp_le_u32 s40, 2
    s_cbranch_scc1 KMC_noskip
    v_mov_b32 v40, v16
    v_mov_b32 v41, v16
    v_mov_b32 v42, v16
    v_mov_b32 v43, v16
    s_cmp_le_u32 s40, 3
    s_cbranch_scc1 KMC_noskip
    v_mov_b32 v44, v16
    v_mov_b32 v45, v16
    v_mov_b32 v46, v16
    v_mov_b32 v47, v16
    s_cmp_le_u32 s40, 4
    s_cbranch_scc1 KMC_noskip
    v_mov_b32 v48, v16
    v_mov_b32 v49, v16
    v_mov_b32 v50, v16
    v_mov_b32 v51, v16
    s_cmp_le_u32 s40, 5
    s_cbranch_scc1 KMC_noskip
    v_mov_b32 v52, v16
    v_mov_b32 v53, v16
    v_mov_b32 v54, v16
    v_mov_b32 v55, v16
    s_cmp_le_u32 s40, 6
    s_cbranch_scc1 KMC_noskip
    v_mov_b32 v56, v16
    v_mov_b32 v57, v16
    v_mov_b32 v58, v16
    v_mov_b32 v59, v16
    s_cmp_le_u32 s40, 7
    s_cbranch_scc1 KMC_noskip
    v_mov_b32 v60, v16
    v_mov_b32 v61, v16
    v_mov_b32 v62, v16
    v_mov_b32 v63, v16
    s_cmp_le_u32 s40, 8
    s_cbranch_scc1 KMC_noskip
    v_mov_b32 v64, v16
    v_mov_b32 v65, v16
    v_mov_b32 v66, v16
    v_mov_b32 v67, v16
    s_cmp_le_u32 s40, 9
    s_cbranch_scc1 KMC_noskip
    v_mov_b32 v68, v16
    v_mov_b32 v69, v16
    v_mov_b32 v70, v16
    v_mov_b32 v71, v16
    s_cmp_le_u32 s40, 10
    s_cbranch_scc1 KMC_noskip
    v_mov_b32 v72, v16
    v_mov_b32 v73, v16
    v_mov_b32 v74, v16
    v_mov_b32 v75, v16
    s_cmp_le_u32 s40, 11
    s_cbranch_scc1 KMC_noskip
    v_mov_b32 v76, v16
    v_mov_b32 v77, v16
    v_mov_b32 v78, v16
    v_mov_b32 v79, v16
    s_cmp_le_u32 s40, 12
    s_cbranch_scc1 KMC_noskip
    v_mov_b32 v80, v16
    v_mov_b32 v81, v16
    v_mov_b32 v82, v16
    v_mov_b32 v83, v16
    s_cmp_le_u32 s40, 13
    s_cbranch_scc1 KMC_noskip
    v_mov_b32 v84, v16
    v_mov_b32 v85, v16
    v_mov_b32 v86, v16
    v_mov_b32 v87, v16
    s_cmp_le_u32 s40, 14
    s_cbranch_scc1 KMC_noskip
    v_mov_b32 v88, v16
    v_mov_b32 v89, v16
    v_mov_b32 v90, v16
    v_mov_b32 v91, v16
    s_cmp_le_u32 s40, 15
    s_cbranch_scc1 KMC_noskip
    v_mov_b32 v92, v16
    v_mov_b32 v93, v16
    v_mov_b32 v94, v16
    v_mov_b32 v95, v16
KMC_noskip:
    v_max3_f32 v17, v32, v33, v34
    v_max3_f32 v17, v17, v35, v36
    v_max3_f32 v17, v17, v37, v38
    v_max3_f32 v17, v17, v39, v40
    v_max3_f32 v17, v17, v41, v42
    v_max3_f32 v17, v17, v43, v44
    v_max3_f32 v17, v17, v45, v46
    v_max3_f32 v17, v17, v47, v48
    v_max3_f32 v17, v17, v49, v50
    v_max3_f32 v17, v17, v51, v52
    v_max3_f32 v17, v17, v53, v54
    v_max3_f32 v17, v17, v55, v56
    v_max3_f32 v17, v17, v57, v58
    v_max3_f32 v17, v17, v59, v60
    v_max3_f32 v17, v17, v61, v62
    v_max3_f32 v17, v17, v63, v64
    v_max3_f32 v17, v17, v65, v66
    v_max3_f32 v17, v17, v67, v68
    v_max3_f32 v17, v17, v69, v70
    v_max3_f32 v17, v17, v71, v72
    v_max3_f32 v17, v17, v73, v74
    v_max3_f32 v17, v17, v75, v76
    v_max3_f32 v17, v17, v77, v78
    v_max3_f32 v17, v17, v79, v80
    v_max3_f32 v17, v17, v81, v82
    v_max3_f32 v17, v17, v83, v84
    v_max3_f32 v17, v17, v85, v86
    v_max3_f32 v17, v17, v87, v88
    v_max3_f32 v17, v17, v89, v90
    v_max3_f32 v17, v17, v91, v92
    v_max3_f32 v17, v17, v93, v94
    v_max3_f32 v17, v17, v95, v96
    v_max3_f32 v17, v17, v97, v98
    v_max_f32 v17, v17, v99
    v_mov_b32 v18, v17
    s_nop 1
    v_permlane32_swap_b32 v17, v18
    s_nop 1
    v_max_f32 v17, v17, v18
    v_mov_b32 v18, v17
    s_nop 1
    v_permlane16_swap_b32 v17, v18
    s_nop 1
    v_max_f32 v17, v17, v18
    s_mov_b32 s41, 0x3e8b97f6
    v_mul_f32 v17, s41, v17
    v_mov_b32 v18, 0
    v_fma_f32 v32, v32, s41, -v17
    v_exp_f32 v32, v32
    v_fma_f32 v33, v33, s41, -v17
    v_exp_f32 v33, v33
    v_fma_f32 v34, v34, s41, -v17
    v_exp_f32 v34, v34
    v_fma_f32 v35, v35, s41, -v17
    v_exp_f32 v35, v35
    v_fma_f32 v36, v36, s41, -v17
    v_exp_f32 v36, v36
    v_fma_f32 v37, v37, s41, -v17
    v_exp_f32 v37, v37
    v_fma_f32 v38, v38, s41, -v17
    v_exp_f32 v38, v38
    v_fma_f32 v39, v39, s41, -v17
    v_exp_f32 v39, v39
    v_fma_f32 v40, v40, s41, -v17
    v_exp_f32 v40, v40
    v_fma_f32 v41, v41, s41, -v17
    v_exp_f32 v41, v41
    v_fma_f32 v42, v42, s41, -v17
    v_exp_f32 v42, v42
    v_fma_f32 v43, v43, s41, -v17
    v_exp_f32 v43, v43
    v_fma_f32 v44, v44, s41, -v17
    v_exp_f32 v44, v44
    v_fma_f32 v45, v45, s41, -v17
    v_exp_f32 v45, v45
    v_fma_f32 v46, v46, s41, -v17
    v_exp_f32 v46, v46
    v_fma_f32 v47, v47, s41, -v17
    v_exp_f32 v47, v47
    v_fma_f32 v48, v48, s41, -v17
    v_exp_f32 v48, v48
    v_fma_f32 v49, v49, s41, -v17
    v_exp_f32 v49, v49
    v_fma_f32 v50, v50, s41, -v17
    v_exp_f32 v50, v50
    v_fma_f32 v51, v51, s41, -v17
    v_exp_f32 v51, v51
    v_fma_f32 v52, v52, s41, -v17
    v_exp_f32 v52, v52
    v_fma_f32 v53, v53, s41, -v17
    v_exp_f32 v53, v53
    v_fma_f32 v54, v54, s41, -v17
    v_exp_f32 v54, v54
    v_fma_f32 v55, v55, s41, -v17
    v_exp_f32 v55, v55
    v_fma_f32 v56, v56, s41, -v17
    v_exp_f32 v56, v56
    v_fma_f32 v57, v57, s41, -v17
    v_exp_f32 v57, v57
    v_fma_f32 v58, v58, s41, -v17
    v_exp_f32 v58, v58
    v_fma_f32 v59, v59, s41, -v17
    v_exp_f32 v59, v59
    v_fma_f32 v60, v60, s41, -v17
    v_exp_f32 v60, v60
    v_fma_f32 v61, v61, s41, -v17
    v_exp_f32 v61, v61
    v_fma_f32 v62, v62, s41, -v17
    v_exp_f32 v62, v62
    v_fma_f32 v63, v63, s41, -v17
    v_exp_f32 v63, v63
    v_fma_f32 v64, v64, s41, -v17
    v_exp_f32 v64, v64
    v_fma_f32 v65, v65, s41, -v17
    v_exp_f32 v65, v65
    v_fma_f32 v66, v66, s41, -v17
    v_exp_f32 v66, v66
    v_fma_f32 v67, v67, s41, -v17
    v_exp_f32 v67, v67
    v_fma_f32 v68, v68, s41, -v17
    v_exp_f32 v68, v68
    v_fma_f32 v69, v69, s41, -v17
    v_exp_f32 v69, v69
    v_fma_f32 v70, v70, s41, -v17
    v_exp_f32 v70, v70
    v_fma_f32 v71, v71, s41, -v17
    v_exp_f32 v71, v71
    v_fma_f32 v72, v72, s41, -v17
    v_exp_f32 v72, v72
    v_fma_f32 v73, v73, s41, -v17
    v_exp_f32 v73, v73
    v_fma_f32 v74, v74, s41, -v17
    v_exp_f32 v74, v74
    v_fma_f32 v75, v75, s41, -v17
    v_exp_f32 v75, v75
    v_fma_f32 v76, v76, s41, -v17
    v_exp_f32 v76, v76
    v_fma_f32 v77, v77, s41, -v17
    v_exp_f32 v77, v77
    v_fma_f32 v78, v78, s41, -v17
    v_exp_f32 v78, v78
    v_fma_f32 v79, v79, s41, -v17
    v_exp_f32 v79, v79
    v_fma_f32 v80, v80, s41, -v17
    v_exp_f32 v80, v80
    v_fma_f32 v81, v81, s41, -v17
    v_exp_f32 v81, v81
    v_fma_f32 v82, v82, s41, -v17
    v_exp_f32 v82, v82
    v_fma_f32 v83, v83, s41, -v17
    v_exp_f32 v83, v83
    v_fma_f32 v84, v84, s41, -v17
    v_exp_f32 v84, v84
    v_fma_f32 v85, v85, s41, -v17
    v_exp_f32 v85, v85
    v_fma_f32 v86, v86, s41, -v17
    v_exp_f32 v86, v86
    v_fma_f32 v87, v87, s41, -v17
    v_exp_f32 v87, v87
    v_fma_f32 v88, v88, s41, -v17
    v_exp_f32 v88, v88
    v_fma_f32 v89, v89, s41, -v17
    v_exp_f32 v89, v89
    v_fma_f32 v90, v90, s41, -v17
    v_exp_f32 v90, v90
    v_fma_f32 v91, v91, s41, -v17
    v_exp_f32 v91, v91
    v_fma_f32 v92, v92, s41, -v17
    v_exp_f32 v92, v92
    v_fma_f32 v93, v93, s41, -v17
    v_exp_f32 v93, v93
    v_fma_f32 v94, v94, s41, -v17
    v_exp_f32 v94, v94
    v_fma_f32 v95, v95, s41, -v17
    v_exp_f32 v95, v95
    v_fma_f32 v96, v96, s41, -v17
    v_exp_f32 v96, v96
    v_fma_f32 v97, v97, s41, -v17
    v_exp_f32 v97, v97
    v_fma_f32 v98, v98, s41, -v17
    v_exp_f32 v98, v98
    v_fma_f32 v99, v99, s41, -v17
    v_exp_f32 v99, v99
    v_add_f32 v18, v18, v32
    v_add_f32 v18, v18, v33
    v_add_f32 v18, v18, v34
    v_add_f32 v18, v18, v35
    v_add_f32 v18, v18, v36
    v_add_f32 v18, v18, v37
    v_add_f32 v18, v18, v38
    v_add_f32 v18, v18, v39
    v_add_f32 v18, v18, v40
    v_add_f32 v18, v18, v41
    v_add_f32 v18, v18, v42
    v_add_f32 v18, v18, v43
    v_add_f32 v18, v18, v44
    v_add_f32 v18, v18, v45
    v_add_f32 v18, v18, v46
    v_add_f32 v18, v18, v47
    v_add_f32 v18, v18, v48
    v_add_f32 v18, v18, v49
    v_add_f32 v18, v18, v50
    v_add_f32 v18, v18, v51
    v_add_f32 v18, v18, v52
    v_add_f32 v18, v18, v53
    v_add_f32 v18, v18, v54
    v_add_f32 v18, v18, v55
    v_add_f32 v18, v18, v56
    v_add_f32 v18, v18, v57
    v_add_f32 v18, v18, v58
    v_add_f32 v18, v18, v59
    v_add_f32 v18, v18, v60
    v_add_f32 v18, v18, v61
    v_add_f32 v18, v18, v62
    v_add_f32 v18, v18, v63
    v_add_f32 v18, v18, v64
    v_add_f32 v18, v18, v65
    v_add_f32 v18, v18, v66
    v_add_f32 v18, v18, v67
    v_add_f32 v18, v18, v68
    v_add_f32 v18, v18, v69
    v_add_f32 v18, v18, v70
    v_add_f32 v18, v18, v71
    v_add_f32 v18, v18, v72
    v_add_f32 v18, v18, v73
    v_add_f32 v18, v18, v74
    v_add_f32 v18, v18, v75
    v_add_f32 v18, v18, v76
    v_add_f32 v18, v18, v77
    v_add_f32 v18, v18, v78
    v_add_f32 v18, v18, v79
    v_add_f32 v18, v18, v80
    v_add_f32 v18, v18, v81
    v_add_f32 v18, v18, v82
    v_add_f32 v18, v18, v83
    v_add_f32 v18, v18, v84
    v_add_f32 v18, v18, v85
    v_add_f32 v18, v18, v86
    v_add_f32 v18, v18, v87
    v_add_f32 v18, v18, v88
    v_add_f32 v18, v18, v89
    v_add_f32 v18, v18, v90
    v_add_f32 v18, v18, v91
    v_add_f32 v18, v18, v92
    v_add_f32 v18, v18, v93
    v_add_f32 v18, v18, v94
    v_add_f32 v18, v18, v95
    v_add_f32 v18, v18, v96
    v_add_f32 v18, v18, v97
    v_add_f32 v18, v18, v98
    v_add_f32 v18, v18, v99
    v_cvt_pk_bf16_f32 v116, v32, v33
    v_cvt_pk_bf16_f32 v117, v34, v35
    v_cvt_pk_bf16_f32 v118, v36, v37
    v_cvt_pk_bf16_f32 v119, v38, v39
    v_cvt_pk_bf16_f32 v120, v40, v41
    v_cvt_pk_bf16_f32 v121, v42, v43
    v_cvt_pk_bf16_f32 v122, v44, v45
    v_cvt_pk_bf16_f32 v123, v46, v47
    v_cvt_pk_bf16_f32 v124, v48, v49
    v_cvt_pk_bf16_f32 v125, v50, v51
    v_cvt_pk_bf16_f32 v126, v52, v53
    v_cvt_pk_bf16_f32 v127, v54, v55
    v_cvt_pk_bf16_f32 v128, v56, v57
    v_cvt_pk_bf16_f32 v129, v58, v59
    v_cvt_pk_bf16_f32 v130, v60, v61
    v_cvt_pk_bf16_f32 v131, v62, v63
    v_cvt_pk_bf16_f32 v132, v64, v65
    v_cvt_pk_bf16_f32 v133, v66, v67
    v_cvt_pk_bf16_f32 v134, v68, v69
    v_cvt_pk_bf16_f32 v135, v70, v71
    v_cvt_pk_bf16_f32 v136, v72, v73
    v_cvt_pk_bf16_f32 v137, v74, v75
    v_cvt_pk_bf16_f32 v138, v76, v77
    v_cvt_pk_bf16_f32 v139, v78, v79
    v_cvt_pk_bf16_f32 v140, v80, v81
    v_cvt_pk_bf16_f32 v141, v82, v83
    v_cvt_pk_bf16_f32 v142, v84, v85
    v_cvt_pk_bf16_f32 v143, v86, v87
    v_cvt_pk_bf16_f32 v144, v88, v89
    v_cvt_pk_bf16_f32 v145, v90, v91
    v_cvt_pk_bf16_f32 v146, v92, v93
    v_cvt_pk_bf16_f32 v147, v94, v95
    v_cvt_pk_bf16_f32 v148, v96, v97
    v_cvt_pk_bf16_f32 v149, v98, v99
    v_mov_b32 v19, v18
    s_nop 1
    v_permlane32_swap_b32 v18, v19
    s_nop 1
    v_add_f32 v18, v18, v19
    v_mov_b32 v19, v18
    s_nop 1
    v_permlane16_swap_b32 v18, v19
    s_nop 1
    v_add_f32 v18, v18, v19
    ds_read_b64_tr_b16 v[32:33], v14 offset:24576
    ds_read_b64_tr_b16 v[34:35], v15 offset:24576
    ds_read_b64_tr_b16 v[36:37], v14 offset:25600
    ds_read_b64_tr_b16 v[38:39], v15 offset:25600
    ds_read_b64_tr_b16 v[40:41], v14 offset:26624
    ds_read_b64_tr_b16 v[42:43], v15 offset:26624
    ds_read_b64_tr_b16 v[44:45], v14 offset:27648
    ds_read_b64_tr_b16 v[46:47], v15 offset:27648
    ds_read_b64_tr_b16 v[48:49], v14 offset:28672
    ds_read_b64_tr_b16 v[50:51], v15 offset:28672
    ds_read_b64_tr_b16 v[52:53], v14 offset:29696
    ds_read_b64_tr_b16 v[54:55], v15 offset:29696
    ds_read_b64_tr_b16 v[56:57], v14 offset:30720
    ds_read_b64_tr_b16 v[58:59], v15 offset:30720
    ds_read_b64_tr_b16 v[60:61], v14 offset:31744
    ds_read_b64_tr_b16 v[62:63], v15 offset:31744
    ds_read_b64_tr_b16 v[64:65], v14 offset:32768
    ds_read_b64_tr_b16 v[66:67], v15 offset:32768
    ds_read_b64_tr_b16 v[68:69], v14 offset:33792
    ds_read_b64_tr_b16 v[70:71], v15 offset:33792
    ds_read_b64_tr_b16 v[72:73], v14 offset:34816
    ds_read_b64_tr_b16 v[74:75], v15 offset:34816
    ds_read_b64_tr_b16 v[76:77], v14 offset:35840
    ds_read_b64_tr_b16 v[78:79], v15 offset:35840
    ds_read_b64_tr_b16 v[80:81], v14 offset:36864
    ds_read_b64_tr_b16 v[82:83], v15 offset:36864
    ds_read_b64_tr_b16 v[84:85], v14 offset:37888
    ds_read_b64_tr_b16 v[86:87], v15 offset:37888
    ds_read_b64_tr_b16 v[88:89], v14 offset:38912
    ds_read_b64_tr_b16 v[90:91], v15 offset:38912
    ds_read_b64_tr_b16 v[92:93], v14 offset:39936
    ds_read_b64_tr_b16 v[94:95], v15 offset:39936
    ds_read_b64_tr_b16 v[96:97], v14 offset:40960
    ds_read_b64_tr_b16 v[100:101], v14 offset:41984
    v_mov_b32 v20, 0
    v_mov_b32 v21, 0
    v_mov_b32 v22, 0
    v_mov_b32 v23, 0
    v_mov_b32 v24, 0
    v_mov_b32 v25, 0
    v_mov_b32 v26, 0
    v_mov_b32 v27, 0
    v_rcp_f32 v18, v18
    s_cmp_eq_u32 s40, 0
    s_cbranch_scc1 KMC_nov
    s_waitcnt lgkmcnt(0)
    s_cmp_le_u32 s40, 0
    s_cbranch_scc1 KMC_nov
    v_mov_b32 v32, 0
    v_mov_b32 v33, 0
    v_mov_b32 v36, 0
    v_mov_b32 v37, 0
    s_cmp_le_u32 s40, 1
    s_cbranch_scc1 KMC_nov
    v_mov_b32 v34, 0
    v_mov_b32 v35, 0
    v_mov_b32 v38, 0
    v_mov_b32 v39, 0
    s_cmp_le_u32 s40, 2
    s_cbranch_scc1 KMC_nov
    v_mov_b32 v40, 0
    v_mov_b32 v41, 0
    v_mov_b32 v44, 0
    v_mov_b32 v45, 0
    s_cmp_le_u32 s40, 3
    s_cbranch_scc1 KMC_nov
    v_mov_b32 v42, 0
    v_mov_b32 v43, 0
    v_mov_b32 v46, 0
    v_mov_b32 v47, 0
    s_cmp_le_u32 s40, 4
    s_cbranch_scc1 KMC_nov
    v_mov_b32 v48, 0
    v_mov_b32 v49, 0
    v_mov_b32 v52, 0
    v_mov_b32 v53, 0
    s_cmp_le_u32 s40, 5
    s_cbranch_scc1 KMC_nov
    v_mov_b32 v50, 0
    v_mov_b32 v51, 0
    v_mov_b32 v54, 0
    v_mov_b32 v55, 0
    s_cmp_le_u32 s40, 6
    s_cbranch_scc1 KMC_nov
    v_mov_b32 v56, 0
    v_mov_b32 v57, 0
    v_mov_b32 v60, 0
    v_mov_b32 v61, 0
    s_cmp_le_u32 s40, 7
    s_cbranch_scc1 KMC_nov
    v_mov_b32 v58, 0
    v_mov_b32 v59, 0
    v_mov_b32 v62, 0
    v_mov_b32 v63, 0
    s_cmp_le_u32 s40, 8
    s_cbranch_scc1 KMC_nov
    v_mov_b32 v64, 0
    v_mov_b32 v65, 0
    v_mov_b32 v68, 0
    v_mov_b32 v69, 0
    s_cmp_le_u32 s40, 9
    s_cbranch_scc1 KMC_nov
    v_mov_b32 v66, 0
    v_mov_b32 v67, 0
    v_mov_b32 v70, 0
    v_mov_b32 v71, 0
    s_cmp_le_u32 s40, 10
    s_cbranch_scc1 KMC_nov
    v_mov_b32 v72, 0
    v_mov_b32 v73, 0
    v_mov_b32 v76, 0
    v_mov_b32 v77, 0
    s_cmp_le_u32 s40, 11
    s_cbranch_scc1 KMC_nov
    v_mov_b32 v74, 0
    v_mov_b32 v75, 0
    v_mov_b32 v78, 0
    v_mov_b32 v79, 0
    s_cmp_le_u32 s40, 12
    s_cbranch_scc1 KMC_nov
    v_mov_b32 v80, 0
    v_mov_b32 v81, 0
    v_mov_b32 v84, 0
    v_mov_b32 v85, 0
    s_cmp_le_u32 s40, 13
    s_cbranch_scc1 KMC_nov
    v_mov_b32 v82, 0
    v_mov_b32 v83, 0
    v_mov_b32 v86, 0
    v_mov_b32 v87, 0
    s_cmp_le_u32 s40, 14
    s_cbranch_scc1 KMC_nov
    v_mov_b32 v88, 0
    v_mov_b32 v89, 0
    v_mov_b32 v92, 0
    v_mov_b32 v93, 0
    s_cmp_le_u32 s40, 15
    s_cbranch_scc1 KMC_nov
    v_mov_b32 v90, 0
    v_mov_b32 v91, 0
    v_mov_b32 v94, 0
    v_mov_b32 v95, 0
KMC_nov:
    s_nop 1
    s_waitcnt lgkmcnt(15)
    v_mfma_f32_16x16x32_bf16 v[20:23], v[32:35], v[116:119], v[20:23]
    s_waitcnt lgkmcnt(15)
    v_mfma_f32_16x16x32_bf16 v[24:27], v[36:39], v[116:119], v[24:27]
    s_waitcnt lgkmcnt(15)
    v_mfma_f32_16x16x32_bf16 v[20:23], v[40:43], v[120:123], v[20:23]
    s_waitcnt lgkmcnt(15)
    v_mfma_f32_16x16x32_bf16 v[24:27], v[44:47], v[120:123], v[24:27]
    s_waitcnt lgkmcnt(15)
    v_mfma_f32_16x16x32_bf16 v[20:23], v[48:51], v[124:127], v[20:23]
    s_waitcnt lgkmcnt(15)
    v_mfma_f32_16x16x32_bf16 v[24:27], v[52:55], v[124:127], v[24:27]
    s_waitcnt lgkmcnt(15)
    v_mfma_f32_16x16x32_bf16 v[20:23], v[56:59], v[128:131], v[20:23]
    s_waitcnt lgkmcnt(15)
    v_mfma_f32_16x16x32_bf16 v[24:27], v[60:63], v[128:131], v[24:27]
    s_waitcnt lgkmcnt(15)
    v_mfma_f32_16x16x32_bf16 v[20:23], v[64:67], v[132:135], v[20:23]
    s_waitcnt lgkmcnt(14)
    v_mfma_f32_16x16x32_bf16 v[24:27], v[68:71], v[132:135], v[24:27]
    s_waitcnt lgkmcnt(12)
    v_mfma_f32_16x16x32_bf16 v[20:23], v[72:75], v[136:139], v[20:23]
    s_waitcnt lgkmcnt(10)
    v_mfma_f32_16x16x32_bf16 v[24:27], v[76:79], v[136:139], v[24:27]
    s_waitcnt lgkmcnt(8)
    v_mfma_f32_16x16x32_bf16 v[20:23], v[80:83], v[140:143], v[20:23]
    s_waitcnt lgkmcnt(6)
    v_mfma_f32_16x16x32_bf16 v[24:27], v[84:87], v[140:143], v[24:27]
    s_waitcnt lgkmcnt(4)
    v_mfma_f32_16x16x32_bf16 v[20:23], v[88:91], v[144:147], v[20:23]
    s_waitcnt lgkmcnt(2)
    v_mfma_f32_16x16x32_bf16 v[24:27], v[92:95], v[144:147], v[24:27]
    s_waitcnt lgkmcnt(1)
    v_mfma_f32_16x16x16_bf16 v[20:23], v[96:97], v[148:149], v[20:23]
    s_waitcnt lgkmcnt(0)
    v_mfma_f32_16x16x16_bf16 v[24:27], v[100:101], v[148:149], v[24:27]
    s_nop 7
    s_nop 3
    v_mul_f32 v20, v20, v18
    v_mul_f32 v21, v21, v18
    v_mul_f32 v22, v22, v18
    v_mul_f32 v23, v23, v18
    v_mul_f32 v24, v24, v18
    v_mul_f32 v25, v25, v18
    v_mul_f32 v26, v26, v18
    v_mul_f32 v27, v27, v18
    v_cvt_pk_bf16_f32 v28, v20, v21
    v_cvt_pk_bf16_f32 v29, v22, v23
    v_cvt_pk_bf16_f32 v30, v24, v25
    v_cvt_pk_bf16_f32 v31, v26, v27
    v_and_b32 v7, 1, v5
    v_lshlrev_b32 v16, 9, v7
    v_lshl_add_u32 v16, v4, 4, v16
    v_lshrrev_b32 v7, 1, v5
    v_lshl_add_u32 v16, v7, 3, v16
    s_lshl_b32 s35, s34, 15
    s_lshl_b32 s36, s25, 11
    s_add_u32 s35, s35, s36
    s_and_b32 s36, s26, 1
    s_lshl_b32 s36, s36, 8
    s_add_u32 s35, s35, s36
    s_add_u32 s35, s35, 8388608
    buffer_store_dwordx2 v[28:29], v16, s[8:11], s35 offen sc1
    buffer_store_dwordx2 v[30:31], v16, s[8:11], s35 offen offset:1024 sc1
    s_cmp_lg_u32 s26, 0
    s_cbranch_scc1 WL6_bar
    s_mov_b64 s[42:43], exec
    s_mov_b64 exec, 255
    v_lshlrev_b32 v3, 9, v1
    s_mov_b32 s41, 32542720
    s_mov_b32 s40, 0
    v_mov_b32 v5, 32
WL6_loop:
    buffer_load_dword v4, v3, s[8:11], s41 offen sc1
    s_waitcnt vmcnt(0)
    v_cmp_lt_u32 vcc, v4, v5
    s_add_u32 s40, s40, 1
    s_cmp_ge_u32 s40, 0x40000
    s_cbranch_scc1 WL6_done
    s_nop 2
    s_cbranch_vccz WL6_done
    s_sleep 2
    s_branch WL6_loop
WL6_done:
    s_mov_b64 exec, s[42:43]
WL6_bar:
    s_waitcnt vmcnt(0)
    s_barrier
    s_cmp_lg_u32 s26, 0
    s_cbranch_scc1 SIG7
    s_mov_b64 s[40:41], exec
    s_mov_b64 exec, 1
    v_mov_b32 v3, 0
    v_mov_b32 v4, 1
    s_lshl_b32 s42, s24, 9
    s_add_u32 s42, s42, 32514048
    buffer_atomic_add v4, v3, s[8:11], s42 offen
    s_mov_b64 exec, s[40:41]
SIG7:
    s_cmp_lt_u32 s25, 14
    s_cbranch_scc1 KM_d
    s_lshl_b32 s34, s24, 1
    s_add_u32 s34, s34, s25
    s_sub_u32 s34, s34, 14
    s_lshl_b32 s34, s34, 1
    s_add_u32 s34, s34, s26
    s_cmp_ge_u32 s26, 2
    s_cbranch_scc1 KM_utdone
    s_cmp_ge_u32 s34, 56
    s_cbranch_scc1 KM_utdone
    v_and_b32 v4, 31, v1
    v_lshrrev_b32 v5, 5, v1
    v_mov_b32 v6, 7168
    v_mov_b32 v7, 5376
    v_cmp_eq_u32 vcc, 0, v4
    s_nop 1
    v_cndmask_b32 v6, v7, v6, vcc
    v_lshl_add_u32 v6, v5, 4, v6
    v_mov_b32 v7, 0x7f000000
    v_cmp_gt_u32 s[46:47], 2, v4
    s_nop 1
    v_cndmask_b32 v6, v7, v6, s[46:47]
    v_cndmask_b32 v8, 0, 1.0, vcc
    s_mul_i32 s35, s34, 28672
    s_add_u32 s35, s35, 24117248
    v_accvgpr_write_b32 a0, 0
    v_accvgpr_write_b32 a1, 0
    v_accvgpr_write_b32 a2, 0
    v_accvgpr_write_b32 a3, 0
    v_accvgpr_write_b32 a4, 0
    v_accvgpr_write_b32 a5, 0
    v_accvgpr_write_b32 a6, 0
    v_accvgpr_write_b32 a7, 0
    v_accvgpr_write_b32 a8, 0
    v_accvgpr_write_b32 a9, 0
    v_accvgpr_write_b32 a10, 0
    v_accvgpr_write_b32 a11, 0
    v_accvgpr_write_b32 a12, 0
    v_accvgpr_write_b32 a13, 0
    v_accvgpr_write_b32 a14, 0
    v_accvgpr_write_b32 a15, 0
    s_add_u32 s36, s35, 0
    buffer_load_dwordx4 v[16:19], v2, s[8:11], s36 offen offset:0
    buffer_load_dwordx4 v[72:75], v6, s[8:11], 0 offen offset:0
    buffer_load_dwordx4 v[76:79], v6, s[8:11], 0 offen offset:32
    buffer_load_dwordx4 v[20:23], v2, s[8:11], s36 offen offset:1024
    buffer_load_dwordx4 v[80:83], v6, s[8:11], 0 offen offset:64
    buffer_load_dwordx4 v[84:87], v6, s[8:11], 0 offen offset:96
    buffer_load_dwordx4 v[24:27], v2, s[8:11], s36 offen offset:2048
    buffer_load_dwordx4 v[88:91], v6, s[8:11], 0 offen offset:128
    buffer_load_dwordx4 v[92:95], v6, s[8:11], 0 offen offset:160
    buffer_load_dwordx4 v[28:31], v2, s[8:11], s36 offen offset:3072
    buffer_load_dwordx4 v[96:99], v6, s[8:11], 0 offen offset:192
    buffer_load_dwordx4 v[100:103], v6, s[8:11], 0 offen offset:224
    s_add_u32 s36, s35, 4096
    buffer_load_dwordx4 v[32:35], v2, s[8:11], s36 offen offset:0
    buffer_load_dwordx4 v[104:107], v6, s[8:11], 0 offen offset:256
    buffer_load_dwordx4 v[108:111], v6, s[8:11], 0 offen offset:288
    buffer_load_dwordx4 v[36:39], v2, s[8:11], s36 offen offset:1024
    buffer_load_dwordx4 v[112:115], v6, s[8:11], 0 offen offset:320
    buffer_load_dwordx4 v[116:119], v6, s[8:11], 0 offen offset:352
    buffer_load_dwordx4 v[40:43], v2, s[8:11], s36 offen offset:2048
    buffer_load_dwordx4 v[120:123], v6, s[8:11], 0 offen offset:384
    buffer_load_dwordx4 v[124:127], v6, s[8:11], 0 offen offset:416
    buffer_load_dwordx4 v[44:47], v2, s[8:11], s36 offen offset:3072
    buffer_load_dwordx4 v[128:131], v6, s[8:11], 0 offen offset:448
    buffer_load_dwordx4 v[132:135], v6, s[8:11], 0 offen offset:480
    s_add_u32 s36, s35, 8192
    buffer_load_dwordx4 v[48:51], v2, s[8:11], s36 offen offset:0
    buffer_load_dwordx4 v[136:139], v6, s[8:11], 0 offen offset:512
    buffer_load_dwordx4 v[140:143], v6, s[8:11], 0 offen offset:544
    buffer_load_dwordx4 v[52:55], v2, s[8:11], s36 offen offset:1024
    buffer_load_dwordx4 v[144:147], v6, s[8:11], 0 offen offset:576
    buffer_load_dwordx4 v[148:151], v6, s[8:11], 0 offen offset:608
    buffer_load_dwordx4 v[56:59], v2, s[8:11], s36 offen offset:2048
    buffer_load_dwordx4 v[152:155], v6, s[8:11], 0 offen offset:640
    buffer_load_dwordx4 v[156:159], v6, s[8:11], 0 offen offset:672
    buffer_load_dwordx4 v[60:63], v2, s[8:11], s36 offen offset:3072
    buffer_load_dwordx4 v[160:163], v6, s[8:11], 0 offen offset:704
    buffer_load_dwordx4 v[164:167], v6, s[8:11], 0 offen offset:736
    s_add_u32 s36, s35, 12288
    buffer_load_dwordx4 v[64:67], v2, s[8:11], s36 offen offset:0
    buffer_load_dwordx4 v[168:171], v6, s[8:11], 0 offen offset:768
    buffer_load_dwordx4 v[172:175], v6, s[8:11], 0 offen offset:800
    buffer_load_dwordx4 v[68:71], v2, s[8:11], s36 offen offset:1024
    buffer_load_dwordx4 v[176:179], v6, s[8:11], 0 offen offset:832
    buffer_load_dwordx4 v[180:183], v6, s[8:11], 0 offen offset:864
    s_waitcnt vmcnt(39)
    v_add_f32 v72, v72, v8
    v_add_f32 v73, v73, v8
    v_add_f32 v74, v74, v8
    v_add_f32 v75, v75, v8
    v_add_f32 v76, v76, v8
    v_add_f32 v77, v77, v8
    v_add_f32 v78, v78, v8
    v_add_f32 v79, v79, v8
    v_cvt_pk_bf16_f32 v72, v72, v73
    v_cvt_pk_bf16_f32 v73, v74, v75
    v_cvt_pk_bf16_f32 v74, v76, v77
    v_cvt_pk_bf16_f32 v75, v78, v79
    s_nop 1
    v_mfma_f32_32x32x16_bf16 a[0:15], v[16:19], v[72:75], a[0:15]
    s_waitcnt vmcnt(36)
    v_add_f32 v80, v80, v8
    v_add_f32 v81, v81, v8
    v_add_f32 v82, v82, v8
    v_add_f32 v83, v83, v8
    v_add_f32 v84, v84, v8
    v_add_f32 v85, v85, v8
    v_add_f32 v86, v86, v8
    v_add_f32 v87, v87, v8
    v_cvt_pk_bf16_f32 v80, v80, v81
    v_cvt_pk_bf16_f32 v81, v82, v83
    v_cvt_pk_bf16_f32 v82, v84, v85
    v_cvt_pk_bf16_f32 v83, v86, v87
    s_nop 1
    v_mfma_f32_32x32x16_bf16 a[0:15], v[20:23], v[80:83], a[0:15]
    s_waitcnt vmcnt(33)
    v_add_f32 v88, v88, v8
    v_add_f32 v89, v89, v8
    v_add_f32 v90, v90, v8
    v_add_f32 v91, v91, v8
    v_add_f32 v92, v92, v8
    v_add_f32 v93, v93, v8
    v_add_f32 v94, v94, v8
    v_add_f32 v95, v95, v8
    v_cvt_pk_bf16_f32 v88, v88, v89
    v_cvt_pk_bf16_f32 v89, v90, v91
    v_cvt_pk_bf16_f32 v90, v92, v93
    v_cvt_pk_bf16_f32 v91, v94, v95
    s_nop 1
    v_mfma_f32_32x32x16_bf16 a[0:15], v[24:27], v[88:91], a[0:15]
    s_waitcnt vmcnt(30)
    v_add_f32 v96, v96, v8
    v_add_f32 v97, v97, v8
    v_add_f32 v98, v98, v8
    v_add_f32 v99, v99, v8
    v_add_f32 v100, v100, v8
    v_add_f32 v101, v101, v8
    v_add_f32 v102, v102, v8
    v_add_f32 v103, v103, v8
    v_cvt_pk_bf16_f32 v96, v96, v97
    v_cvt_pk_bf16_f32 v97, v98, v99
    v_cvt_pk_bf16_f32 v98, v100, v101
    v_cvt_pk_bf16_f32 v99, v102, v103
    s_nop 1
    v_mfma_f32_32x32x16_bf16 a[0:15], v[28:31], v[96:99], a[0:15]
    s_waitcnt vmcnt(27)
    v_add_f32 v104, v104, v8
    v_add_f32 v105, v105, v8
    v_add_f32 v106, v106, v8
    v_add_f32 v107, v107, v8
    v_add_f32 v108, v108, v8
    v_add_f32 v109, v109, v8
    v_add_f32 v110, v110, v8
    v_add_f32 v111, v111, v8
    v_cvt_pk_bf16_f32 v104, v104, v105
    v_cvt_pk_bf16_f32 v105, v106, v107
    v_cvt_pk_bf16_f32 v106, v108, v109
    v_cvt_pk_bf16_f32 v107, v110, v111
    s_nop 1
    v_mfma_f32_32x32x16_bf16 a[0:15], v[32:35], v[104:107], a[0:15]
    s_waitcnt vmcnt(24)
    v_add_f32 v112, v112, v8
    v_add_f32 v113, v113, v8
    v_add_f32 v114, v114, v8
    v_add_f32 v115, v115, v8
    v_add_f32 v116, v116, v8
    v_add_f32 v117, v117, v8
    v_add_f32 v118, v118, v8
    v_add_f32 v119, v119, v8
    v_cvt_pk_bf16_f32 v112, v112, v113
    v_cvt_pk_bf16_f32 v113, v114, v115
    v_cvt_pk_bf16_f32 v114, v116, v117
    v_cvt_pk_bf16_f32 v115, v118, v119
    s_nop 1
    v_mfma_f32_32x32x16_bf16 a[0:15], v[36:39], v[112:115], a[0:15]
    s_waitcnt vmcnt(21)
    v_add_f32 v120, v120, v8
    v_add_f32 v121, v121, v8
    v_add_f32 v122, v122, v8
    v_add_f32 v123, v123, v8
    v_add_f32 v124, v124, v8
    v_add_f32 v125, v125, v8
    v_add_f32 v126, v126, v8
    v_add_f32 v127, v127, v8
    v_cvt_pk_bf16_f32 v120, v120, v121
    v_cvt_pk_bf16_f32 v121, v122, v123
    v_cvt_pk_bf16_f32 v122, v124, v125
    v_cvt_pk_bf16_f32 v123, v126, v127
    s_nop 1
    v_mfma_f32_32x32x16_bf16 a[0:15], v[40:43], v[120:123], a[0:15]
    s_waitcnt vmcnt(18)
    v_add_f32 v128, v128, v8
    v_add_f32 v129, v129, v8
    v_add_f32 v130, v130, v8
    v_add_f32 v131, v131, v8
    v_add_f32 v132, v132, v8
    v_add_f32 v133, v133, v8
    v_add_f32 v134, v134, v8
    v_add_f32 v135, v135, v8
    v_cvt_pk_bf16_f32 v128, v128, v129
    v_cvt_pk_bf16_f32 v129, v130, v131
    v_cvt_pk_bf16_f32 v130, v132, v133
    v_cvt_pk_bf16_f32 v131, v134, v135
    s_nop 1
    v_mfma_f32_32x32x16_bf16 a[0:15], v[44:47], v[128:131], a[0:15]
    s_waitcnt vmcnt(15)
    v_add_f32 v136, v136, v8
    v_add_f32 v137, v137, v8
    v_add_f32 v138, v138, v8
    v_add_f32 v139, v139, v8
    v_add_f32 v140, v140, v8
    v_add_f32 v141, v141, v8
    v_add_f32 v142, v142, v8
    v_add_f32 v143, v143, v8
    v_cvt_pk_bf16_f32 v136, v136, v137
    v_cvt_pk_bf16_f32 v137, v138, v139
    v_cvt_pk_bf16_f32 v138, v140, v141
    v_cvt_pk_bf16_f32 v139, v142, v143
    s_nop 1
    v_mfma_f32_32x32x16_bf16 a[0:15], v[48:51], v[136:139], a[0:15]
    s_waitcnt vmcnt(12)
    v_add_f32 v144, v144, v8
    v_add_f32 v145, v145, v8
    v_add_f32 v146, v146, v8
    v_add_f32 v147, v147, v8
    v_add_f32 v148, v148, v8
    v_add_f32 v149, v149, v8
    v_add_f32 v150, v150, v8
    v_add_f32 v151, v151, v8
    v_cvt_pk_bf16_f32 v144, v144, v145
    v_cvt_pk_bf16_f32 v145, v146, v147
    v_cvt_pk_bf16_f32 v146, v148, v149
    v_cvt_pk_bf16_f32 v147, v150, v151
    s_nop 1
    v_mfma_f32_32x32x16_bf16 a[0:15], v[52:55], v[144:147], a[0:15]
    s_waitcnt vmcnt(9)
    v_add_f32 v152, v152, v8
    v_add_f32 v153, v153, v8
    v_add_f32 v154, v154, v8
    v_add_f32 v155, v155, v8
    v_add_f32 v156, v156, v8
    v_add_f32 v157, v157, v8
    v_add_f32 v158, v158, v8
    v_add_f32 v159, v159, v8
    v_cvt_pk_bf16_f32 v152, v152, v153
    v_cvt_pk_bf16_f32 v153, v154, v155
    v_cvt_pk_bf16_f32 v154, v156, v157
    v_cvt_pk_bf16_f32 v155, v158, v159
    s_nop 1
    v_mfma_f32_32x32x16_bf16 a[0:15], v[56:59], v[152:155], a[0:15]
    s_waitcnt vmcnt(6)
    v_add_f32 v160, v160, v8
    v_add_f32 v161, v161, v8
    v_add_f32 v162, v162, v8
    v_add_f32 v163, v163, v8
    v_add_f32 v164, v164, v8
    v_add_f32 v165, v165, v8
    v_add_f32 v166, v166, v8
    v_add_f32 v167, v167, v8
    v_cvt_pk_bf16_f32 v160, v160, v161
    v_cvt_pk_bf16_f32 v161, v162, v163
    v_cvt_pk_bf16_f32 v162, v164, v165
    v_cvt_pk_bf16_f32 v163, v166, v167
    s_nop 1
    v_mfma_f32_32x32x16_bf16 a[0:15], v[60:63], v[160:163], a[0:15]
    s_waitcnt vmcnt(3)
    v_add_f32 v168, v168, v8
    v_add_f32 v169, v169, v8
    v_add_f32 v170, v170, v8
    v_add_f32 v171, v171, v8
    v_add_f32 v172, v172, v8
    v_add_f32 v173, v173, v8
    v_add_f32 v174, v174, v8
    v_add_f32 v175, v175, v8
    v_cvt_pk_bf16_f32 v168, v168, v169
    v_cvt_pk_bf16_f32 v169, v170, v171
    v_cvt_pk_bf16_f32 v170, v172, v173
    v_cvt_pk_bf16_f32 v171, v174, v175
    s_nop 1
    v_mfma_f32_32x32x16_bf16 a[0:15], v[64:67], v[168:171], a[0:15]
    s_waitcnt vmcnt(0)
    v_add_f32 v176, v176, v8
    v_add_f32 v177, v177, v8
    v_add_f32 v178, v178, v8
    v_add_f32 v179, v179, v8
    v_add_f32 v180, v180, v8
    v_add_f32 v181, v181, v8
    v_add_f32 v182, v182, v8
    v_add_f32 v183, v183, v8
    v_cvt_pk_bf16_f32 v176, v176, v177
    v_cvt_pk_bf16_f32 v177, v178, v179
    v_cvt_pk_bf16_f32 v178, v180, v181
    v_cvt_pk_bf16_f32 v179, v182, v183
    s_nop 1
    v_mfma_f32_32x32x16_bf16 a[0:15], v[68:71], v[176:179], a[0:15]
    buffer_load_dwordx4 v[16:19], v2, s[8:11], s36 offen offset:2048
    buffer_load_dwordx4 v[72:75], v6, s[8:11], 0 offen offset:896
    buffer_load_dwordx4 v[76:79], v6, s[8:11], 0 offen offset:928
    buffer_load_dwordx4 v[20:23], v2, s[8:11], s36 offen offset:3072
    buffer_load_dwordx4 v[80:83], v6, s[8:11], 0 offen offset:960
    buffer_load_dwordx4 v[84:87], v6, s[8:11], 0 offen offset:992
    s_add_u32 s36, s35, 16384
    buffer_load_dwordx4 v[24:27], v2, s[8:11], s36 offen offset:0
    buffer_load_dwordx4 v[88:91], v6, s[8:11], 0 offen offset:1024
    buffer_load_dwordx4 v[92:95], v6, s[8:11], 0 offen offset:1056
    buffer_load_dwordx4 v[28:31], v2, s[8:11], s36 offen offset:1024
    buffer_load_dwordx4 v[96:99], v6, s[8:11], 0 offen offset:1088
    buffer_load_dwordx4 v[100:103], v6, s[8:11], 0 offen offset:1120
    buffer_load_dwordx4 v[32:35], v2, s[8:11], s36 offen offset:2048
    buffer_load_dwordx4 v[104:107], v6, s[8:11], 0 offen offset:1152
    buffer_load_dwordx4 v[108:111], v6, s[8:11], 0 offen offset:1184
    buffer_load_dwordx4 v[36:39], v2, s[8:11], s36 offen offset:3072
    buffer_load_dwordx4 v[112:115], v6, s[8:11], 0 offen offset:1216
    buffer_load_dwordx4 v[116:119], v6, s[8:11], 0 offen offset:1248
    s_add_u32 s36, s35, 20480
    buffer_load_dwordx4 v[40:43], v2, s[8:11], s36 offen offset:0
    buffer_load_dwordx4 v[120:123], v6, s[8:11], 0 offen offset:1280
    buffer_load_dwordx4 v[124:127], v6, s[8:11], 0 offen offset:1312
    buffer_load_dwordx4 v[44:47], v2, s[8:11], s36 offen offset:1024
    buffer_load_dwordx4 v[128:131], v6, s[8:11], 0 offen offset:1344
    buffer_load_dwordx4 v[132:135], v6, s[8:11], 0 offen offset:1376
    buffer_load_dwordx4 v[48:51], v2, s[8:11], s36 offen offset:2048
    buffer_load_dwordx4 v[136:139], v6, s[8:11], 0 offen offset:1408
    buffer_load_dwordx4 v[140:143], v6, s[8:11], 0 offen offset:1440
    buffer_load_dwordx4 v[52:55], v2, s[8:11], s36 offen offset:3072
    buffer_load_dwordx4 v[144:147], v6, s[8:11], 0 offen offset:1472
    buffer_load_dwordx4 v[148:151], v6, s[8:11], 0 offen offset:1504
    s_add_u32 s36, s35, 24576
    buffer_load_dwordx4 v[56:59], v2, s[8:11], s36 offen offset:0
    buffer_load_dwordx4 v[152:155], v6, s[8:11], 0 offen offset:1536
    buffer_load_dwordx4 v[156:159], v6, s[8:11], 0 offen offset:1568
    buffer_load_dwordx4 v[60:63], v2, s[8:11], s36 offen offset:1024
    buffer_load_dwordx4 v[160:163], v6, s[8:11], 0 offen offset:1600
    buffer_load_dwordx4 v[164:167], v6, s[8:11], 0 offen offset:1632
    buffer_load_dwordx4 v[64:67], v2, s[8:11], s36 offen offset:2048
    buffer_load_dwordx4 v[168:171], v6, s[8:11], 0 offen offset:1664
    buffer_load_dwordx4 v[172:175], v6, s[8:11], 0 offen offset:1696
    buffer_load_dwordx4 v[68:71], v2, s[8:11], s36 offen offset:3072
    buffer_load_dwordx4 v[176:179], v6, s[8:11], 0 offen offset:1728
    buffer_load_dwordx4 v[180:183], v6, s[8:11], 0 offen offset:1760
    s_waitcnt vmcnt(39)
    v_add_f32 v72, v72, v8
    v_add_f32 v73, v73, v8
    v_add_f32 v74, v74, v8
    v_add_f32 v75, v75, v8
    v_add_f32 v76, v76, v8
    v_add_f32 v77, v77, v8
    v_add_f32 v78, v78, v8
    v_add_f32 v79, v79, v8
    v_cvt_pk_bf16_f32 v72, v72, v73
    v_cvt_pk_bf16_f32 v73, v74, v75
    v_cvt_pk_bf16_f32 v74, v76, v77
    v_cvt_pk_bf16_f32 v75, v78, v79
    s_nop 1
    v_mfma_f32_32x32x16_bf16 a[0:15], v[16:19], v[72:75], a[0:15]
    s_waitcnt vmcnt(36)
    v_add_f32 v80, v80, v8
    v_add_f32 v81, v81, v8
    v_add_f32 v82, v82, v8
    v_add_f32 v83, v83, v8
    v_add_f32 v84, v84, v8
    v_add_f32 v85, v85, v8
    v_add_f32 v86, v86, v8
    v_add_f32 v87, v87, v8
    v_cvt_pk_bf16_f32 v80, v80, v81
    v_cvt_pk_bf16_f32 v81, v82, v83
    v_cvt_pk_bf16_f32 v82, v84, v85
    v_cvt_pk_bf16_f32 v83, v86, v87
    s_nop 1
    v_mfma_f32_32x32x16_bf16 a[0:15], v[20:23], v[80:83], a[0:15]
    s_waitcnt vmcnt(33)
    v_add_f32 v88, v88, v8
    v_add_f32 v89, v89, v8
    v_add_f32 v90, v90, v8
    v_add_f32 v91, v91, v8
    v_add_f32 v92, v92, v8
    v_add_f32 v93, v93, v8
    v_add_f32 v94, v94, v8
    v_add_f32 v95, v95, v8
    v_cvt_pk_bf16_f32 v88, v88, v89
    v_cvt_pk_bf16_f32 v89, v90, v91
    v_cvt_pk_bf16_f32 v90, v92, v93
    v_cvt_pk_bf16_f32 v91, v94, v95
    s_nop 1
    v_mfma_f32_32x32x16_bf16 a[0:15], v[24:27], v[88:91], a[0:15]
    s_waitcnt vmcnt(30)
    v_add_f32 v96, v96, v8
    v_add_f32 v97, v97, v8
    v_add_f32 v98, v98, v8
    v_add_f32 v99, v99, v8
    v_add_f32 v100, v100, v8
    v_add_f32 v101, v101, v8
    v_add_f32 v102, v102, v8
    v_add_f32 v103, v103, v8
    v_cvt_pk_bf16_f32 v96, v96, v97
    v_cvt_pk_bf16_f32 v97, v98, v99
    v_cvt_pk_bf16_f32 v98, v100, v101
    v_cvt_pk_bf16_f32 v99, v102, v103
    s_nop 1
    v_mfma_f32_32x32x16_bf16 a[0:15], v[28:31], v[96:99], a[0:15]
    s_waitcnt vmcnt(27)
    v_add_f32 v104, v104, v8
    v_add_f32 v105, v105, v8
    v_add_f32 v106, v106, v8
    v_add_f32 v107, v107, v8
    v_add_f32 v108, v108, v8
    v_add_f32 v109, v109, v8
    v_add_f32 v110, v110, v8
    v_add_f32 v111, v111, v8
    v_cvt_pk_bf16_f32 v104, v104, v105
    v_cvt_pk_bf16_f32 v105, v106, v107
    v_cvt_pk_bf16_f32 v106, v108, v109
    v_cvt_pk_bf16_f32 v107, v110, v111
    s_nop 1
    v_mfma_f32_32x32x16_bf16 a[0:15], v[32:35], v[104:107], a[0:15]
    s_waitcnt vmcnt(24)
    v_add_f32 v112, v112, v8
    v_add_f32 v113, v113, v8
    v_add_f32 v114, v114, v8
    v_add_f32 v115, v115, v8
    v_add_f32 v116, v116, v8
    v_add_f32 v117, v117, v8
    v_add_f32 v118, v118, v8
    v_add_f32 v119, v119, v8
    v_cvt_pk_bf16_f32 v112, v112, v113
    v_cvt_pk_bf16_f32 v113, v114, v115
    v_cvt_pk_bf16_f32 v114, v116, v117
    v_cvt_pk_bf16_f32 v115, v118, v119
    s_nop 1
    v_mfma_f32_32x32x16_bf16 a[0:15], v[36:39], v[112:115], a[0:15]
    s_waitcnt vmcnt(21)
    v_add_f32 v120, v120, v8
    v_add_f32 v121, v121, v8
    v_add_f32 v122, v122, v8
    v_add_f32 v123, v123, v8
    v_add_f32 v124, v124, v8
    v_add_f32 v125, v125, v8
    v_add_f32 v126, v126, v8
    v_add_f32 v127, v127, v8
    v_cvt_pk_bf16_f32 v120, v120, v121
    v_cvt_pk_bf16_f32 v121, v122, v123
    v_cvt_pk_bf16_f32 v122, v124, v125
    v_cvt_pk_bf16_f32 v123, v126, v127
    s_nop 1
    v_mfma_f32_32x32x16_bf16 a[0:15], v[40:43], v[120:123], a[0:15]
    s_waitcnt vmcnt(18)
    v_add_f32 v128, v128, v8
    v_add_f32 v129, v129, v8
    v_add_f32 v130, v130, v8
    v_add_f32 v131, v131, v8
    v_add_f32 v132, v132, v8
    v_add_f32 v133, v133, v8
    v_add_f32 v134, v134, v8
    v_add_f32 v135, v135, v8
    v_cvt_pk_bf16_f32 v128, v128, v129
    v_cvt_pk_bf16_f32 v129, v130, v131
    v_cvt_pk_bf16_f32 v130, v132, v133
    v_cvt_pk_bf16_f32 v131, v134, v135
    s_nop 1
    v_mfma_f32_32x32x16_bf16 a[0:15], v[44:47], v[128:131], a[0:15]
    s_waitcnt vmcnt(15)
    v_add_f32 v136, v136, v8
    v_add_f32 v137, v137, v8
    v_add_f32 v138, v138, v8
    v_add_f32 v139, v139, v8
    v_add_f32 v140, v140, v8
    v_add_f32 v141, v141, v8
    v_add_f32 v142, v142, v8
    v_add_f32 v143, v143, v8
    v_cvt_pk_bf16_f32 v136, v136, v137
    v_cvt_pk_bf16_f32 v137, v138, v139
    v_cvt_pk_bf16_f32 v138, v140, v141
    v_cvt_pk_bf16_f32 v139, v142, v143
    s_nop 1
    v_mfma_f32_32x32x16_bf16 a[0:15], v[48:51], v[136:139], a[0:15]
    s_waitcnt vmcnt(12)
    v_add_f32 v144, v144, v8
    v_add_f32 v145, v145, v8
    v_add_f32 v146, v146, v8
    v_add_f32 v147, v147, v8
    v_add_f32 v148, v148, v8
    v_add_f32 v149, v149, v8
    v_add_f32 v150, v150, v8
    v_add_f32 v151, v151, v8
    v_cvt_pk_bf16_f32 v144, v144, v145
    v_cvt_pk_bf16_f32 v145, v146, v147
    v_cvt_pk_bf16_f32 v146, v148, v149
    v_cvt_pk_bf16_f32 v147, v150, v151
    s_nop 1
    v_mfma_f32_32x32x16_bf16 a[0:15], v[52:55], v[144:147], a[0:15]
    s_waitcnt vmcnt(9)
    v_add_f32 v152, v152, v8
    v_add_f32 v153, v153, v8
    v_add_f32 v154, v154, v8
    v_add_f32 v155, v155, v8
    v_add_f32 v156, v156, v8
    v_add_f32 v157, v157, v8
    v_add_f32 v158, v158, v8
    v_add_f32 v159, v159, v8
    v_cvt_pk_bf16_f32 v152, v152, v153
    v_cvt_pk_bf16_f32 v153, v154, v155
    v_cvt_pk_bf16_f32 v154, v156, v157
    v_cvt_pk_bf16_f32 v155, v158, v159
    s_nop 1
    v_mfma_f32_32x32x16_bf16 a[0:15], v[56:59], v[152:155], a[0:15]
    s_waitcnt vmcnt(6)
    v_add_f32 v160, v160, v8
    v_add_f32 v161, v161, v8
    v_add_f32 v162, v162, v8
    v_add_f32 v163, v163, v8
    v_add_f32 v164, v164, v8
    v_add_f32 v165, v165, v8
    v_add_f32 v166, v166, v8
    v_add_f32 v167, v167, v8
    v_cvt_pk_bf16_f32 v160, v160, v161
    v_cvt_pk_bf16_f32 v161, v162, v163
    v_cvt_pk_bf16_f32 v162, v164, v165
    v_cvt_pk_bf16_f32 v163, v166, v167
    s_nop 1
    v_mfma_f32_32x32x16_bf16 a[0:15], v[60:63], v[160:163], a[0:15]
    s_waitcnt vmcnt(3)
    v_add_f32 v168, v168, v8
    v_add_f32 v169, v169, v8
    v_add_f32 v170, v170, v8
    v_add_f32 v171, v171, v8
    v_add_f32 v172, v172, v8
    v_add_f32 v173, v173, v8
    v_add_f32 v174, v174, v8
    v_add_f32 v175, v175, v8
    v_cvt_pk_bf16_f32 v168, v168, v169
    v_cvt_pk_bf16_f32 v169, v170, v171
    v_cvt_pk_bf16_f32 v170, v172, v173
    v_cvt_pk_bf16_f32 v171, v174, v175
    s_nop 1
    v_mfma_f32_32x32x16_bf16 a[0:15], v[64:67], v[168:171], a[0:15]
    s_waitcnt vmcnt(0)
    v_add_f32 v176, v176, v8
    v_add_f32 v177, v177, v8
    v_add_f32 v178, v178, v8
    v_add_f32 v179, v179, v8
    v_add_f32 v180, v180, v8
    v_add_f32 v181, v181, v8
    v_add_f32 v182, v182, v8
    v_add_f32 v183, v183, v8
    v_cvt_pk_bf16_f32 v176, v176, v177
    v_cvt_pk_bf16_f32 v177, v178, v179
    v_cvt_pk_bf16_f32 v178, v180, v181
    v_cvt_pk_bf16_f32 v179, v182, v183
    s_nop 1
    v_mfma_f32_32x32x16_bf16 a[0:15], v[68:71], v[176:179], a[0:15]
    s_nop 7
    s_nop 7
    v_lshlrev_b32 v6, 7, v4
    v_lshl_add_u32 v6, v5, 4, v6
    s_lshl_b32 s35, s34, 8
    s_add_u32 s35, s35, 31457280
    s_and_saveexec_b64 s[48:49], s[46:47]
    buffer_store_dwordx4 a[0:3], v6, s[8:11], s35 offen offset:0 sc1
    buffer_store_dwordx4 a[4:7], v6, s[8:11], s35 offen offset:32 sc1
    buffer_store_dwordx4 a[8:11], v6, s[8:11], s35 offen offset:64 sc1
    buffer_store_dwordx4 a[12:15], v6, s[8:11], s35 offen offset:96 sc1
    s_waitcnt vmcnt(0)
    s_mov_b64 exec, 1
    v_mov_b32 v3, 0
    v_mov_b32 v4, 1
    s_mov_b32 s35, 32555008
    buffer_atomic_add v4, v3, s[8:11], s35 offen
    s_mov_b64 exec, s[48:49]
KM_utdone:
    s_branch KM_fl
KM_d:
    s_cmp_ge_u32 s25, 7
    s_cselect_b32 s36, 1, 0
    s_lshl_b32 s34, s24, 1
    s_add_u32 s34, s34, s36
    s_mul_i32 s36, s36, 7
    s_sub_u32 s35, s25, s36
    s_lshl_b32 s36, s26, 12
    s_lshl_b32 s42, s35, 16
    s_add_u32 s42, s42, s36
    s_add_u32 s42, s42, 23068672
    s_add_u32 s43, s42, 32768
    buffer_load_dwordx4 v[16:19], v2, s[8:11], s42 offen offset:0
    buffer_load_dwordx4 v[20:23], v2, s[8:11], s43 offen offset:0
    buffer_load_dwordx4 v[24:27], v2, s[8:11], s42 offen offset:1024
    buffer_load_dwordx4 v[28:31], v2, s[8:11], s43 offen offset:1024
    buffer_load_dwordx4 v[32:35], v2, s[8:11], s42 offen offset:2048
    buffer_load_dwordx4 v[36:39], v2, s[8:11], s43 offen offset:2048
    buffer_load_dwordx4 v[40:43], v2, s[8:11], s42 offen offset:3072
    buffer_load_dwordx4 v[44:47], v2, s[8:11], s43 offen offset:3072
    s_lshl_b32 s55, s34, 16
    s_add_u32 s55, s55, s36
    s_add_u32 s55, s55, 8388608
    s_bfe_u32 s36, s26, 0x10001
    s_lshr_b32 s37, s26, 2
    s_and_b32 s38, s26, 1
    s_lshl_b32 s39, s35, 1
    s_add_u32 s39, s39, s36
    s_lshl_b32 s54, s34, 1
    s_add_u32 s54, s54, s37
    v_lshrrev_b32 v4, 5, v1
    v_and_b32 v5, 31, v1
    s_lshl_b32 s43, s54, 5
    v_add_u32 v184, s43, v5
    s_movk_i32 s43, 896
    v_mul_lo_u32 v8, v184, s43
    v_lshl_add_u32 v8, v4, 3, v8
    s_lshl_b32 s44, s39, 6
    s_lshl_b32 s43, s38, 5
    s_add_u32 s44, s44, s43
    buffer_load_dwordx2 v[160:161], v8, s[12:15], s44 offen
    buffer_load_dwordx2 v[162:163], v8, s[12:15], s44 offen offset:16
    s_cmp_lg_u32 s26, 7
    s_cbranch_scc1 KMD_nogc
    v_and_b32 v6, 15, v1
    v_lshlrev_b32 v6, 4, v6
    v_mov_b32 v7, 3584
    v_mov_b32 v8, 7168
    v_cmp_gt_u32 vcc, 16, v1
    s_nop 1
    v_cndmask_b32 v7, v8, v7, vcc
    v_add_u32 v6, v6, v7
    v_mov_b32 v7, 0x7f000000
    v_cmp_gt_u32 vcc, 32, v1
    s_nop 1
    v_cndmask_b32 v6, v7, v6, vcc
    s_lshl_b32 s43, s35, 8
    s_mov_b32 m0, 134656
    s_nop 0
    buffer_load_dwordx4 v6, s[8:11], s43 offen lds
    s_waitcnt vmcnt(0)
KMD_nogc:
    s_cmp_lg_u32 s26, 0
    s_cbranch_scc1 WAIT8_bar
    v_mov_b32 v3, 0
    s_mov_b32 s40, 0
    s_sub_i32 s41, s24, 0
    s_max_i32 s41, s41, 0
    s_lshl_b32 s41, s41, 9
    s_add_u32 s41, s41, 32514048
WAIT8_loop:
    buffer_load_dword v4, v3, s[8:11], s41 offen sc1
    s_waitcnt vmcnt(0)
    s_nop 0
    v_readfirstlane_b32 s44, v4
    s_add_u32 s40, s40, 1
    s_cmp_ge_u32 s40, 0x40000
    s_cbranch_scc1 WAIT8_bar
    s_cmp_ge_u32 s44, 16
    s_cbranch_scc1 WAIT8_bar
    s_sleep 2
    s_branch WAIT8_loop
WAIT8_bar:
    s_barrier
    s_add_u32 s43, s55, 32768
    buffer_load_dwordx4 v[48:51], v2, s[8:11], s55 offen offset:0
    buffer_load_dwordx4 v[52:55], v2, s[8:11], s43 offen offset:0
    buffer_load_dwordx4 v[56:59], v2, s[8:11], s55 offen offset:1024
    buffer_load_dwordx4 v[60:63], v2, s[8:11], s43 offen offset:1024
    buffer_load_dwordx4 v[64:67], v2, s[8:11], s55 offen offset:2048
    buffer_load_dwordx4 v[68:71], v2, s[8:11], s43 offen offset:2048
    buffer_load_dwordx4 v[72:75], v2, s[8:11], s55 offen offset:3072
    buffer_load_dwordx4 v[76:79], v2, s[8:11], s43 offen offset:3072
    v_accvgpr_write_b32 a0, 0
    v_accvgpr_write_b32 a1, 0
    v_accvgpr_write_b32 a2, 0
    v_accvgpr_write_b32 a3, 0
    v_accvgpr_write_b32 a4, 0
    v_accvgpr_write_b32 a5, 0
    v_accvgpr_write_b32 a6, 0
    v_accvgpr_write_b32 a7, 0
    v_accvgpr_write_b32 a8, 0
    v_accvgpr_write_b32 a9, 0
    v_accvgpr_write_b32 a10, 0
    v_accvgpr_write_b32 a11, 0
    v_accvgpr_write_b32 a12, 0
    v_accvgpr_write_b32 a13, 0
    v_accvgpr_write_b32 a14, 0
    v_accvgpr_write_b32 a15, 0
    v_accvgpr_write_b32 a16, 0
    v_accvgpr_write_b32 a17, 0
    v_accvgpr_write_b32 a18, 0
    v_accvgpr_write_b32 a19, 0
    v_accvgpr_write_b32 a20, 0
    v_accvgpr_write_b32 a21, 0
    v_accvgpr_write_b32 a22, 0
    v_accvgpr_write_b32 a23, 0
    v_accvgpr_write_b32 a24, 0
    v_accvgpr_write_b32 a25, 0
    v_accvgpr_write_b32 a26, 0
    v_accvgpr_write_b32 a27, 0
    v_accvgpr_write_b32 a28, 0
    v_accvgpr_write_b32 a29, 0
    v_accvgpr_write_b32 a30, 0
    v_accvgpr_write_b32 a31, 0
    v_accvgpr_write_b32 a32, 0
    v_accvgpr_write_b32 a33, 0
    v_accvgpr_write_b32 a34, 0
    v_accvgpr_write_b32 a35, 0
    v_accvgpr_write_b32 a36, 0
    v_accvgpr_write_b32 a37, 0
    v_accvgpr_write_b32 a38, 0
    v_accvgpr_write_b32 a39, 0
    v_accvgpr_write_b32 a40, 0
    v_accvgpr_write_b32 a41, 0
    v_accvgpr_write_b32 a42, 0
    v_accvgpr_write_b32 a43, 0
    v_accvgpr_write_b32 a44, 0
    v_accvgpr_write_b32 a45, 0
    v_accvgpr_write_b32 a46, 0
    v_accvgpr_write_b32 a47, 0
    v_accvgpr_write_b32 a48, 0
    v_accvgpr_write_b32 a49, 0
    v_accvgpr_write_b32 a50, 0
    v_accvgpr_write_b32 a51, 0
    v_accvgpr_write_b32 a52, 0
    v_accvgpr_write_b32 a53, 0
    v_accvgpr_write_b32 a54, 0
    v_accvgpr_write_b32 a55, 0
    v_accvgpr_write_b32 a56, 0
    v_accvgpr_write_b32 a57, 0
    v_accvgpr_write_b32 a58, 0
    v_accvgpr_write_b32 a59, 0
    v_accvgpr_write_b32 a60, 0
    v_accvgpr_write_b32 a61, 0
    v_accvgpr_write_b32 a62, 0
    v_accvgpr_write_b32 a63, 0
    s_lshl_b32 s45, s36, 7
    s_lshl_b32 s43, s38, 6
    s_add_u32 s45, s45, s43
    s_add_u32 s45, s45, 134656
    v_lshrrev_b32 v10, 5, v1
    v_lshlrev_b32 v10, 4, v10
    v_add_u32 v10, s45, v10
    ds_read_b128 v[144:147], v10 offset:0
    ds_read_b128 v[152:155], v10 offset:256
    ds_read_b128 v[148:151], v10 offset:32
    ds_read_b128 v[156:159], v10 offset:288
    s_lshl_b32 s41, s26, 11
    v_add_u32 v9, s41, v2
    v_add_u32 v10, 0x10000, v9
    s_waitcnt vmcnt(6)
    v_mfma_f32_32x32x16_bf16 a[0:15], v[16:19], v[48:51], a[0:15]
    v_mfma_f32_32x32x16_bf16 a[16:31], v[20:23], v[48:51], a[16:31]
    v_mfma_f32_32x32x16_bf16 a[32:47], v[16:19], v[52:55], a[32:47]
    v_mfma_f32_32x32x16_bf16 a[48:63], v[20:23], v[52:55], a[48:63]
    s_waitcnt vmcnt(4)
    v_mfma_f32_32x32x16_bf16 a[0:15], v[24:27], v[56:59], a[0:15]
    v_mfma_f32_32x32x16_bf16 a[16:31], v[28:31], v[56:59], a[16:31]
    v_mfma_f32_32x32x16_bf16 a[32:47], v[24:27], v[60:63], a[32:47]
    v_mfma_f32_32x32x16_bf16 a[48:63], v[28:31], v[60:63], a[48:63]
    s_waitcnt vmcnt(2)
    v_mfma_f32_32x32x16_bf16 a[0:15], v[32:35], v[64:67], a[0:15]
    v_mfma_f32_32x32x16_bf16 a[16:31], v[36:39], v[64:67], a[16:31]
    v_mfma_f32_32x32x16_bf16 a[32:47], v[32:35], v[68:71], a[32:47]
    v_mfma_f32_32x32x16_bf16 a[48:63], v[36:39], v[68:71], a[48:63]
    s_waitcnt vmcnt(0)
    v_mfma_f32_32x32x16_bf16 a[0:15], v[40:43], v[72:75], a[0:15]
    v_mfma_f32_32x32x16_bf16 a[16:31], v[44:47], v[72:75], a[16:31]
    v_mfma_f32_32x32x16_bf16 a[32:47], v[40:43], v[76:79], a[32:47]
    v_mfma_f32_32x32x16_bf16 a[48:63], v[44:47], v[76:79], a[48:63]
    s_waitcnt lgkmcnt(0)
    v_add_f32 v152, 1.0, v152
    v_cvt_pk_bf16_f32 v152, v152, v152
    v_lshlrev_b32 v152, 16, v152
    v_add_f32 v153, 1.0, v153
    v_cvt_pk_bf16_f32 v153, v153, v153
    v_lshlrev_b32 v153, 16, v153
    v_add_f32 v154, 1.0, v154
    v_cvt_pk_bf16_f32 v154, v154, v154
    v_lshlrev_b32 v154, 16, v154
    v_add_f32 v155, 1.0, v155
    v_cvt_pk_bf16_f32 v155, v155, v155
    v_lshlrev_b32 v155, 16, v155
    v_add_f32 v156, 1.0, v156
    v_cvt_pk_bf16_f32 v156, v156, v156
    v_lshlrev_b32 v156, 16, v156
    v_add_f32 v157, 1.0, v157
    v_cvt_pk_bf16_f32 v157, v157, v157
    v_lshlrev_b32 v157, 16, v157
    v_add_f32 v158, 1.0, v158
    v_cvt_pk_bf16_f32 v158, v158, v158
    v_lshlrev_b32 v158, 16, v158
    v_add_f32 v159, 1.0, v159
    v_cvt_pk_bf16_f32 v159, v159, v159
    v_lshlrev_b32 v159, 16, v159
    ds_write_b128 v9, a[0:3] offset:0
    ds_write_b128 v9, a[4:7] offset:1024
    ds_write_b128 v9, a[8:11] offset:16384
    ds_write_b128 v9, a[12:15] offset:17408
    ds_write_b128 v9, a[16:19] offset:32768
    ds_write_b128 v9, a[20:23] offset:33792
    ds_write_b128 v9, a[24:27] offset:49152
    ds_write_b128 v9, a[28:31] offset:50176
    ds_write_b128 v10, a[32:35] offset:0
    ds_write_b128 v10, a[36:39] offset:1024
    ds_write_b128 v10, a[40:43] offset:16384
    ds_write_b128 v10, a[44:47] offset:17408
    ds_write_b128 v10, a[48:51] offset:32768
    ds_write_b128 v10, a[52:55] offset:33792
    ds_write_b128 v10, a[56:59] offset:49152
    ds_write_b128 v10, a[60:63] offset:50176
    s_waitcnt lgkmcnt(0)
    s_barrier
    s_lshl_b32 s41, s26, 14
    v_add_u32 v9, s41, v2
    ds_read_b128 v[80:83], v9 offset:0
    ds_read_b128 v[84:87], v9 offset:1024
    ds_read_b128 v[88:91], v9 offset:2048
    ds_read_b128 v[92:95], v9 offset:3072
    ds_read_b128 v[96:99], v9 offset:4096
    ds_read_b128 v[100:103], v9 offset:5120
    ds_read_b128 v[104:107], v9 offset:6144
    ds_read_b128 v[108:111], v9 offset:7168
    ds_read_b128 v[112:115], v9 offset:8192
    ds_read_b128 v[116:119], v9 offset:9216
    ds_read_b128 v[120:123], v9 offset:10240
    ds_read_b128 v[124:127], v9 offset:11264
    ds_read_b128 v[128:131], v9 offset:12288
    ds_read_b128 v[132:135], v9 offset:13312
    ds_read_b128 v[136:139], v9 offset:14336
    ds_read_b128 v[140:143], v9 offset:15360
    s_waitcnt lgkmcnt(0)
    v_add_f32 v164, v80, v88
    v_add_f32 v165, v81, v89
    v_add_f32 v166, v82, v90
    v_add_f32 v167, v83, v91
    v_add_f32 v168, v84, v92
    v_add_f32 v169, v85, v93
    v_add_f32 v170, v86, v94
    v_add_f32 v171, v87, v95
    v_add_f32 v164, v164, v96
    v_add_f32 v165, v165, v97
    v_add_f32 v166, v166, v98
    v_add_f32 v167, v167, v99
    v_add_f32 v168, v168, v100
    v_add_f32 v169, v169, v101
    v_add_f32 v170, v170, v102
    v_add_f32 v171, v171, v103
    v_add_f32 v164, v164, v104
    v_add_f32 v165, v165, v105
    v_add_f32 v166, v166, v106
    v_add_f32 v167, v167, v107
    v_add_f32 v168, v168, v108
    v_add_f32 v169, v169, v109
    v_add_f32 v170, v170, v110
    v_add_f32 v171, v171, v111
    v_add_f32 v164, v164, v112
    v_add_f32 v165, v165, v113
    v_add_f32 v166, v166, v114
    v_add_f32 v167, v167, v115
    v_add_f32 v168, v168, v116
    v_add_f32 v169, v169, v117
    v_add_f32 v170, v170, v118
    v_add_f32 v171, v171, v119
    v_add_f32 v164, v164, v120
    v_add_f32 v165, v165, v121
    v_add_f32 v166, v166, v122
    v_add_f32 v167, v167, v123
    v_add_f32 v168, v168, v124
    v_add_f32 v169, v169, v125
    v_add_f32 v170, v170, v126
    v_add_f32 v171, v171, v127
    v_add_f32 v164, v164, v128
    v_add_f32 v165, v165, v129
    v_add_f32 v166, v166, v130
    v_add_f32 v167, v167, v131
    v_add_f32 v168, v168, v132
    v_add_f32 v169, v169, v133
    v_add_f32 v170, v170, v134
    v_add_f32 v171, v171, v135
    v_add_f32 v164, v164, v136
    v_add_f32 v165, v165, v137
    v_add_f32 v166, v166, v138
    v_add_f32 v167, v167, v139
    v_add_f32 v168, v168, v140
    v_add_f32 v169, v169, v141
    v_add_f32 v170, v170, v142
    v_add_f32 v171, v171, v143
    v_cvt_pk_bf16_f32 v10, v164, v165
    v_lshlrev_b32 v164, 16, v10
    v_and_b32 v165, 0xffff0000, v10
    v_mul_f32 v164, v164, v144
    v_mul_f32 v165, v165, v145
    v_cvt_pk_bf16_f32 v10, v164, v165
    v_lshlrev_b32 v164, 16, v10
    v_and_b32 v165, 0xffff0000, v10
    v_lshlrev_b32 v11, 16, v160
    v_and_b32 v12, 0xffff0000, v160
    v_add_f32 v164, v164, v11
    v_add_f32 v165, v165, v12
    v_cvt_pk_bf16_f32 v172, v164, v165
    v_cvt_pk_bf16_f32 v10, v166, v167
    v_lshlrev_b32 v166, 16, v10
    v_and_b32 v167, 0xffff0000, v10
    v_mul_f32 v166, v166, v146
    v_mul_f32 v167, v167, v147
    v_cvt_pk_bf16_f32 v10, v166, v167
    v_lshlrev_b32 v166, 16, v10
    v_and_b32 v167, 0xffff0000, v10
    v_lshlrev_b32 v11, 16, v161
    v_and_b32 v12, 0xffff0000, v161
    v_add_f32 v166, v166, v11
    v_add_f32 v167, v167, v12
    v_cvt_pk_bf16_f32 v173, v166, v167
    v_cvt_pk_bf16_f32 v10, v168, v169
    v_lshlrev_b32 v168, 16, v10
    v_and_b32 v169, 0xffff0000, v10
    v_mul_f32 v168, v168, v148
    v_mul_f32 v169, v169, v149
    v_cvt_pk_bf16_f32 v10, v168, v169
    v_lshlrev_b32 v168, 16, v10
    v_and_b32 v169, 0xffff0000, v10
    v_lshlrev_b32 v11, 16, v162
    v_and_b32 v12, 0xffff0000, v162
    v_add_f32 v168, v168, v11
    v_add_f32 v169, v169, v12
    v_cvt_pk_bf16_f32 v174, v168, v169
    v_cvt_pk_bf16_f32 v10, v170, v171
    v_lshlrev_b32 v170, 16, v10
    v_and_b32 v171, 0xffff0000, v10
    v_mul_f32 v170, v170, v150
    v_mul_f32 v171, v171, v151
    v_cvt_pk_bf16_f32 v10, v170, v171
    v_lshlrev_b32 v170, 16, v10
    v_and_b32 v171, 0xffff0000, v10
    v_lshlrev_b32 v11, 16, v163
    v_and_b32 v12, 0xffff0000, v163
    v_add_f32 v170, v170, v11
    v_add_f32 v171, v171, v12
    v_cvt_pk_bf16_f32 v175, v170, v171
    s_mul_i32 s42, s54, 28672
    s_lshl_b32 s43, s39, 11
    s_add_u32 s42, s42, s43
    s_lshl_b32 s43, s38, 10
    s_add_u32 s42, s42, s43
    s_add_u32 s43, s42, 20971520
    s_add_u32 s42, s42, 10485760
    buffer_store_dwordx4 v[172:175], v2, s[8:11], s42 offen sc1
    v_mov_b32 v10, 0
    v_mov_b32 v11, 0
    v_lshlrev_b32 v12, 16, v172
    v_and_b32 v13, 0xffff0000, v172
    v_add_f32 v10, v10, v12
    v_fmac_f32 v11, v12, v12
    v_add_f32 v10, v10, v13
    v_fmac_f32 v11, v13, v13
    v_mul_f32 v12, v12, v152
    v_mul_f32 v13, v13, v153
    v_cvt_pk_bf16_f32 v176, v12, v13
    v_lshlrev_b32 v12, 16, v173
    v_and_b32 v13, 0xffff0000, v173
    v_add_f32 v10, v10, v12
    v_fmac_f32 v11, v12, v12
    v_add_f32 v10, v10, v13
    v_fmac_f32 v11, v13, v13
    v_mul_f32 v12, v12, v154
    v_mul_f32 v13, v13, v155
    v_cvt_pk_bf16_f32 v177, v12, v13
    v_lshlrev_b32 v12, 16, v174
    v_and_b32 v13, 0xffff0000, v174
    v_add_f32 v10, v10, v12
    v_fmac_f32 v11, v12, v12
    v_add_f32 v10, v10, v13
    v_fmac_f32 v11, v13, v13
    v_mul_f32 v12, v12, v156
    v_mul_f32 v13, v13, v157
    v_cvt_pk_bf16_f32 v178, v12, v13
    v_lshlrev_b32 v12, 16, v175
    v_and_b32 v13, 0xffff0000, v175
    v_add_f32 v10, v10, v12
    v_fmac_f32 v11, v12, v12
    v_add_f32 v10, v10, v13
    v_fmac_f32 v11, v13, v13
    v_mul_f32 v12, v12, v158
    v_mul_f32 v13, v13, v159
    v_cvt_pk_bf16_f32 v179, v12, v13
    buffer_store_dwordx4 v[176:179], v2, s[8:11], s43 offen sc1
    v_mov_b32 v12, v10
    v_mov_b32 v13, v11
    s_nop 1
    v_permlane32_swap_b32 v10, v12
    v_permlane32_swap_b32 v11, v13
    s_nop 1
    v_add_f32 v10, v10, v12
    v_add_f32 v11, v11, v13
    s_lshr_b32 s41, s26, 1
    s_lshl_b32 s41, s41, 8
    s_add_u32 s41, s41, 135680
    v_and_b32 v12, 31, v1
    v_lshlrev_b32 v12, 3, v12
    v_add_u32 v12, s41, v12
    s_cmp_eq_u32 s38, 0
    s_cbranch_scc1 KMD_e0
    ds_write_b64 v12, v[10:11]
    s_waitcnt lgkmcnt(0)
    s_barrier
    s_branch KMD_end
KMD_e0:
    s_barrier
    ds_read_b64 v[14:15], v12
    s_movk_i32 s43, 112
    v_mul_lo_u32 v12, v184, s43
    s_lshl_b32 s43, s39, 3
    s_add_u32 s43, s43, 12582912
    v_cmp_gt_u32 vcc, 32, v1
    s_waitcnt lgkmcnt(0)
    v_add_f32 v10, v10, v14
    v_add_f32 v11, v11, v15
    s_and_saveexec_b64 s[46:47], vcc
    buffer_store_dwordx2 v[10:11], v12, s[8:11], s43 offen sc1
    s_mov_b64 exec, s[46:47]
KMD_end:
    s_mov_b32 s45, 0
    s_cmp_lg_u32 s26, 0
    s_cbranch_scc1 WL9_bar
    s_mov_b64 s[42:43], exec
    s_mov_b64 exec, 1
    v_mov_b32 v3, 0
    s_lshl_b32 s41, s45, 9
    s_add_u32 s41, s41, 32555008
    s_mov_b32 s40, 0
    v_mov_b32 v5, 56
WL9_loop:
    buffer_load_dword v4, v3, s[8:11], s41 offen sc1
    s_waitcnt vmcnt(0)
    v_cmp_lt_u32 vcc, v4, v5
    s_add_u32 s40, s40, 1
    s_cmp_ge_u32 s40, 0x40000
    s_cbranch_scc1 WL9_done
    s_nop 2
    s_cbranch_vccz WL9_done
    s_sleep 2
    s_branch WL9_loop
WL9_done:
    s_mov_b64 exec, s[42:43]
WL9_bar:
    s_waitcnt vmcnt(0)
    s_barrier
    s_cmp_lg_u32 s26, 0
    s_cbranch_scc1 SIG10
    s_mov_b64 s[40:41], exec
    s_mov_b64 exec, 1
    v_mov_b32 v3, 0
    v_mov_b32 v4, 1
    s_lshl_b32 s42, s24, 9
    s_add_u32 s42, s42, 32522240
    buffer_atomic_add v4, v3, s[8:11], s42 offen
    s_mov_b64 exec, s[40:41]
SIG10:
    s_mul_i32 s34, s25, 114688
    s_add_u32 s34, s34, 24117248
    s_lshl_b32 s35, s26, 10
    s_add_u32 s34, s34, s35
    s_add_u32 s36, s35, 0
    s_mov_b32 m0, s36
    s_add_u32 s37, s34, 0
    buffer_load_dwordx4 v2, s[8:11], s37 offen lds
    s_add_u32 s36, s35, 8192
    s_mov_b32 m0, s36
    s_add_u32 s37, s34, 8192
    buffer_load_dwordx4 v2, s[8:11], s37 offen lds
    s_add_u32 s36, s35, 16384
    s_mov_b32 m0, s36
    s_add_u32 s37, s34, 16384
    buffer_load_dwordx4 v2, s[8:11], s37 offen lds
    s_add_u32 s36, s35, 24576
    s_mov_b32 m0, s36
    s_add_u32 s37, s34, 24576
    buffer_load_dwordx4 v2, s[8:11], s37 offen lds
    s_add_u32 s36, s35, 32768
    s_mov_b32 m0, s36
    s_add_u32 s37, s34, 32768
    buffer_load_dwordx4 v2, s[8:11], s37 offen lds
    s_add_u32 s36, s35, 40960
    s_mov_b32 m0, s36
    s_add_u32 s37, s34, 40960
    buffer_load_dwordx4 v2, s[8:11], s37 offen lds
    s_add_u32 s36, s35, 49152
    s_mov_b32 m0, s36
    s_add_u32 s37, s34, 49152
    buffer_load_dwordx4 v2, s[8:11], s37 offen lds
    s_add_u32 s36, s35, 57344
    s_mov_b32 m0, s36
    s_add_u32 s37, s34, 57344
    buffer_load_dwordx4 v2, s[8:11], s37 offen lds
    s_add_u32 s36, s35, 65536
    s_mov_b32 m0, s36
    s_add_u32 s37, s34, 65536
    buffer_load_dwordx4 v2, s[8:11], s37 offen lds
    s_add_u32 s36, s35, 73728
    s_mov_b32 m0, s36
    s_add_u32 s37, s34, 73728
    buffer_load_dwordx4 v2, s[8:11], s37 offen lds
    s_add_u32 s36, s35, 81920
    s_mov_b32 m0, s36
    s_add_u32 s37, s34, 81920
    buffer_load_dwordx4 v2, s[8:11], s37 offen lds
    s_add_u32 s36, s35, 90112
    s_mov_b32 m0, s36
    s_add_u32 s37, s34, 90112
    buffer_load_dwordx4 v2, s[8:11], s37 offen lds
    s_add_u32 s36, s35, 98304
    s_mov_b32 m0, s36
    s_add_u32 s37, s34, 98304
    buffer_load_dwordx4 v2, s[8:11], s37 offen lds
    s_add_u32 s36, s35, 106496
    s_mov_b32 m0, s36
    s_add_u32 s37, s34, 106496
    buffer_load_dwordx4 v2, s[8:11], s37 offen lds
KME_dmaskip:
    s_waitcnt vmcnt(0)
    s_cmp_lg_u32 s26, 0
    s_cbranch_scc1 WAIT11_bar
    v_mov_b32 v3, 0
    s_mov_b32 s40, 0
    s_sub_i32 s41, s24, 0
    s_max_i32 s41, s41, 0
    s_lshl_b32 s41, s41, 9
    s_add_u32 s41, s41, 32522240
WAIT11_loop:
    buffer_load_dword v4, v3, s[8:11], s41 offen sc1
    s_waitcnt vmcnt(0)
    s_nop 0
    v_readfirstlane_b32 s44, v4
    s_add_u32 s40, s40, 1
    s_cmp_ge_u32 s40, 0x40000
    s_cbranch_scc1 WAIT11_bar
    s_cmp_ge_u32 s44, 14
    s_cbranch_scc1 WAIT11_bar
    s_sleep 2
    s_branch WAIT11_loop
WAIT11_bar:
    s_barrier
    s_cmp_ge_u32 s25, 7
    s_cselect_b32 s36, 1, 0
    s_lshl_b32 s34, s24, 1
    s_add_u32 s34, s34, s36
    s_mul_i32 s36, s36, 7
    s_sub_u32 s35, s25, s36
    s_mov_b32 s58, s34
    s_mov_b32 s59, s35
    s_mul_i32 s36, s26, 14336
    s_mul_i32 s62, s35, 229376
    s_add_u32 s62, s62, s36
    s_add_u32 s62, s62, 26214400
    s_add_u32 s63, s62, 114688
    s_mul_i32 s56, s34, 229376
    s_add_u32 s56, s56, s36
    s_add_u32 s56, s56, 13631488
    s_add_u32 s57, s56, 114688
    s_and_b32 s34, s26, 3
    s_lshr_b32 s35, s26, 2
    s_lshl_b32 s36, s24, 2
    s_add_u32 s36, s36, s34
    s_mul_i32 s37, s36, 28672
    s_mul_i32 s38, s35, 14336
    s_add_u32 s37, s37, s38
    s_add_u32 s37, s37, 20971520
    s_add_u32 s39, s37, 0
    buffer_load_dwordx4 v[16:19], v2, s[8:11], s39 offen offset:0
    buffer_load_dwordx4 v[20:23], v2, s[8:11], s39 offen offset:1024
    buffer_load_dwordx4 v[24:27], v2, s[8:11], s39 offen offset:2048
    buffer_load_dwordx4 v[28:31], v2, s[8:11], s39 offen offset:3072
    s_add_u32 s39, s37, 4096
    buffer_load_dwordx4 v[32:35], v2, s[8:11], s39 offen offset:0
    buffer_load_dwordx4 v[36:39], v2, s[8:11], s39 offen offset:1024
    buffer_load_dwordx4 v[40:43], v2, s[8:11], s39 offen offset:2048
    buffer_load_dwordx4 v[44:47], v2, s[8:11], s39 offen offset:3072
    s_add_u32 s39, s37, 8192
    buffer_load_dwordx4 v[48:51], v2, s[8:11], s39 offen offset:0
    buffer_load_dwordx4 v[52:55], v2, s[8:11], s39 offen offset:1024
    buffer_load_dwordx4 v[56:59], v2, s[8:11], s39 offen offset:2048
    buffer_load_dwordx4 v[60:63], v2, s[8:11], s39 offen offset:3072
    s_add_u32 s39, s37, 12288
    buffer_load_dwordx4 v[64:67], v2, s[8:11], s39 offen offset:0
    buffer_load_dwordx4 v[68:71], v2, s[8:11], s39 offen offset:1024
    s_cmp_eq_u32 s26, 7
    s_cbranch_scc1 KME_ut
    s_mul_i32 s39, s24, 14336
    s_lshl_b32 s40, s26, 11
    s_add_u32 s39, s39, s40
    s_add_u32 s39, s39, 12582912
    s_add_u32 s40, s40, 114688
    s_mov_b32 m0, s40
    s_nop 0
    buffer_load_dwordx4 v2, s[8:11], s39 offen lds
    buffer_load_dwordx4 v2, s[8:11], s39 offen offset:1024 lds
    s_branch KME_ut2
KME_ut:
    s_lshl_b32 s39, s25, 10
    s_add_u32 s39, s39, 31457280
    s_mov_b32 m0, 129024
    s_nop 0
    buffer_load_dwordx4 v2, s[8:11], s39 offen lds
    buffer_load_dwordx4 v2, s[8:11], s39 offen lds
KME_ut2:
    buffer_load_dwordx4 v[104:107], v2, s[8:11], s62 offen offset:0
    buffer_load_dwordx4 v[108:111], v2, s[8:11], s63 offen offset:0
    buffer_load_dwordx4 v[112:115], v2, s[8:11], s62 offen offset:1024
    buffer_load_dwordx4 v[116:119], v2, s[8:11], s63 offen offset:1024
    buffer_load_dwordx4 v[120:123], v2, s[8:11], s62 offen offset:2048
    buffer_load_dwordx4 v[124:127], v2, s[8:11], s63 offen offset:2048
    buffer_load_dwordx4 v[128:131], v2, s[8:11], s62 offen offset:3072
    buffer_load_dwordx4 v[132:135], v2, s[8:11], s63 offen offset:3072
    s_add_u32 s62, s62, 4096
    s_add_u32 s63, s63, 4096
    buffer_load_dwordx4 v[136:139], v2, s[8:11], s62 offen offset:0
    buffer_load_dwordx4 v[140:143], v2, s[8:11], s63 offen offset:0
    buffer_load_dwordx4 v[144:147], v2, s[8:11], s62 offen offset:1024
    buffer_load_dwordx4 v[148:151], v2, s[8:11], s63 offen offset:1024
    buffer_load_dwordx4 v[152:155], v2, s[8:11], s62 offen offset:2048
    buffer_load_dwordx4 v[156:159], v2, s[8:11], s63 offen offset:2048
    buffer_load_dwordx4 v[160:163], v2, s[8:11], s62 offen offset:3072
    buffer_load_dwordx4 v[164:167], v2, s[8:11], s63 offen offset:3072
    s_add_u32 s62, s62, 4096
    s_add_u32 s63, s63, 4096
    buffer_load_dwordx4 v[168:171], v2, s[8:11], s62 offen offset:0
    buffer_load_dwordx4 v[172:175], v2, s[8:11], s63 offen offset:0
    buffer_load_dwordx4 v[176:179], v2, s[8:11], s62 offen offset:1024
    buffer_load_dwordx4 v[180:183], v2, s[8:11], s63 offen offset:1024
    buffer_load_dwordx4 v[184:187], v2, s[8:11], s62 offen offset:2048
    buffer_load_dwordx4 v[188:191], v2, s[8:11], s63 offen offset:2048
    v_accvgpr_write_b32 a0, 0
    v_accvgpr_write_b32 a1, 0
    v_accvgpr_write_b32 a2, 0
    v_accvgpr_write_b32 a3, 0
    v_accvgpr_write_b32 a4, 0
    v_accvgpr_write_b32 a5, 0
    v_accvgpr_write_b32 a6, 0
    v_accvgpr_write_b32 a7, 0
    v_accvgpr_write_b32 a8, 0
    v_accvgpr_write_b32 a9, 0
    v_accvgpr_write_b32 a10, 0
    v_accvgpr_write_b32 a11, 0
    v_accvgpr_write_b32 a12, 0
    v_accvgpr_write_b32 a13, 0
    v_accvgpr_write_b32 a14, 0
    v_accvgpr_write_b32 a15, 0
    v_accvgpr_write_b32 a16, 0
    v_accvgpr_write_b32 a17, 0
    v_accvgpr_write_b32 a18, 0
    v_accvgpr_write_b32 a19, 0
    v_accvgpr_write_b32 a20, 0
    v_accvgpr_write_b32 a21, 0
    v_accvgpr_write_b32 a22, 0
    v_accvgpr_write_b32 a23, 0
    v_accvgpr_write_b32 a24, 0
    v_accvgpr_write_b32 a25, 0
    v_accvgpr_write_b32 a26, 0
    v_accvgpr_write_b32 a27, 0
    v_accvgpr_write_b32 a28, 0
    v_accvgpr_write_b32 a29, 0
    v_accvgpr_write_b32 a30, 0
    v_accvgpr_write_b32 a31, 0
    v_accvgpr_write_b32 a32, 0
    v_accvgpr_write_b32 a33, 0
    v_accvgpr_write_b32 a34, 0
    v_accvgpr_write_b32 a35, 0
    v_accvgpr_write_b32 a36, 0
    v_accvgpr_write_b32 a37, 0
    v_accvgpr_write_b32 a38, 0
    v_accvgpr_write_b32 a39, 0
    v_accvgpr_write_b32 a40, 0
    v_accvgpr_write_b32 a41, 0
    v_accvgpr_write_b32 a42, 0
    v_accvgpr_write_b32 a43, 0
    v_accvgpr_write_b32 a44, 0
    v_accvgpr_write_b32 a45, 0
    v_accvgpr_write_b32 a46, 0
    v_accvgpr_write_b32 a47, 0
    v_accvgpr_write_b32 a48, 0
    v_accvgpr_write_b32 a49, 0
    v_accvgpr_write_b32 a50, 0
    v_accvgpr_write_b32 a51, 0
    v_accvgpr_write_b32 a52, 0
    v_accvgpr_write_b32 a53, 0
    v_accvgpr_write_b32 a54, 0
    v_accvgpr_write_b32 a55, 0
    v_accvgpr_write_b32 a56, 0
    v_accvgpr_write_b32 a57, 0
    v_accvgpr_write_b32 a58, 0
    v_accvgpr_write_b32 a59, 0
    v_accvgpr_write_b32 a60, 0
    v_accvgpr_write_b32 a61, 0
    v_accvgpr_write_b32 a62, 0
    v_accvgpr_write_b32 a63, 0
    v_add_u32 v5, s38, v2
    v_add_u32 v7, 0xe000, v5
    ds_read_b128 v[72:75], v5 offset:0
    ds_read_b128 v[76:79], v5 offset:28672
    ds_read_b128 v[80:83], v7 offset:0
    ds_read_b128 v[84:87], v7 offset:28672
    ds_read_b128 v[88:91], v5 offset:1024
    ds_read_b128 v[92:95], v5 offset:29696
    ds_read_b128 v[96:99], v7 offset:1024
    ds_read_b128 v[100:103], v7 offset:29696
    s_waitcnt vmcnt(37) lgkmcnt(4)
    v_mfma_f32_32x32x16_bf16 a[0:15], v[72:75], v[16:19], a[0:15]
    v_mfma_f32_32x32x16_bf16 a[16:31], v[76:79], v[16:19], a[16:31]
    v_mfma_f32_32x32x16_bf16 a[32:47], v[80:83], v[16:19], a[32:47]
    v_mfma_f32_32x32x16_bf16 a[48:63], v[84:87], v[16:19], a[48:63]
    ds_read_b128 v[72:75], v5 offset:2048
    ds_read_b128 v[76:79], v5 offset:30720
    ds_read_b128 v[80:83], v7 offset:2048
    ds_read_b128 v[84:87], v7 offset:30720
    s_waitcnt vmcnt(36) lgkmcnt(4)
    v_mfma_f32_32x32x16_bf16 a[0:15], v[88:91], v[20:23], a[0:15]
    v_mfma_f32_32x32x16_bf16 a[16:31], v[92:95], v[20:23], a[16:31]
    v_mfma_f32_32x32x16_bf16 a[32:47], v[96:99], v[20:23], a[32:47]
    v_mfma_f32_32x32x16_bf16 a[48:63], v[100:103], v[20:23], a[48:63]
    ds_read_b128 v[88:91], v5 offset:3072
    ds_read_b128 v[92:95], v5 offset:31744
    ds_read_b128 v[96:99], v7 offset:3072
    ds_read_b128 v[100:103], v7 offset:31744
    s_waitcnt vmcnt(35) lgkmcnt(4)
    v_mfma_f32_32x32x16_bf16 a[0:15], v[72:75], v[24:27], a[0:15]
    v_mfma_f32_32x32x16_bf16 a[16:31], v[76:79], v[24:27], a[16:31]
    v_mfma_f32_32x32x16_bf16 a[32:47], v[80:83], v[24:27], a[32:47]
    v_mfma_f32_32x32x16_bf16 a[48:63], v[84:87], v[24:27], a[48:63]
    ds_read_b128 v[72:75], v5 offset:4096
    ds_read_b128 v[76:79], v5 offset:32768
    ds_read_b128 v[80:83], v7 offset:4096
    ds_read_b128 v[84:87], v7 offset:32768
    s_waitcnt vmcnt(34) lgkmcnt(4)
    v_mfma_f32_32x32x16_bf16 a[0:15], v[88:91], v[28:31], a[0:15]
    v_mfma_f32_32x32x16_bf16 a[16:31], v[92:95], v[28:31], a[16:31]
    v_mfma_f32_32x32x16_bf16 a[32:47], v[96:99], v[28:31], a[32:47]
    v_mfma_f32_32x32x16_bf16 a[48:63], v[100:103], v[28:31], a[48:63]
    ds_read_b128 v[88:91], v5 offset:5120
    ds_read_b128 v[92:95], v5 offset:33792
    ds_read_b128 v[96:99], v7 offset:5120
    ds_read_b128 v[100:103], v7 offset:33792
    s_waitcnt vmcnt(33) lgkmcnt(4)
    v_mfma_f32_32x32x16_bf16 a[0:15], v[72:75], v[32:35], a[0:15]
    v_mfma_f32_32x32x16_bf16 a[16:31], v[76:79], v[32:35], a[16:31]
    v_mfma_f32_32x32x16_bf16 a[32:47], v[80:83], v[32:35], a[32:47]
    v_mfma_f32_32x32x16_bf16 a[48:63], v[84:87], v[32:35], a[48:63]
    ds_read_b128 v[72:75], v5 offset:6144
    ds_read_b128 v[76:79], v5 offset:34816
    ds_read_b128 v[80:83], v7 offset:6144
    ds_read_b128 v[84:87], v7 offset:34816
    s_waitcnt vmcnt(32) lgkmcnt(4)
    v_mfma_f32_32x32x16_bf16 a[0:15], v[88:91], v[36:39], a[0:15]
    v_mfma_f32_32x32x16_bf16 a[16:31], v[92:95], v[36:39], a[16:31]
    v_mfma_f32_32x32x16_bf16 a[32:47], v[96:99], v[36:39], a[32:47]
    v_mfma_f32_32x32x16_bf16 a[48:63], v[100:103], v[36:39], a[48:63]
    ds_read_b128 v[88:91], v5 offset:7168
    ds_read_b128 v[92:95], v5 offset:35840
    ds_read_b128 v[96:99], v7 offset:7168
    ds_read_b128 v[100:103], v7 offset:35840
    s_waitcnt vmcnt(31) lgkmcnt(4)
    v_mfma_f32_32x32x16_bf16 a[0:15], v[72:75], v[40:43], a[0:15]
    v_mfma_f32_32x32x16_bf16 a[16:31], v[76:79], v[40:43], a[16:31]
    v_mfma_f32_32x32x16_bf16 a[32:47], v[80:83], v[40:43], a[32:47]
    v_mfma_f32_32x32x16_bf16 a[48:63], v[84:87], v[40:43], a[48:63]
    ds_read_b128 v[72:75], v5 offset:8192
    ds_read_b128 v[76:79], v5 offset:36864
    ds_read_b128 v[80:83], v7 offset:8192
    ds_read_b128 v[84:87], v7 offset:36864
    s_waitcnt vmcnt(30) lgkmcnt(4)
    v_mfma_f32_32x32x16_bf16 a[0:15], v[88:91], v[44:47], a[0:15]
    v_mfma_f32_32x32x16_bf16 a[16:31], v[92:95], v[44:47], a[16:31]
    v_mfma_f32_32x32x16_bf16 a[32:47], v[96:99], v[44:47], a[32:47]
    v_mfma_f32_32x32x16_bf16 a[48:63], v[100:103], v[44:47], a[48:63]
    ds_read_b128 v[88:91], v5 offset:9216
    ds_read_b128 v[92:95], v5 offset:37888
    ds_read_b128 v[96:99], v7 offset:9216
    ds_read_b128 v[100:103], v7 offset:37888
    s_waitcnt vmcnt(29) lgkmcnt(4)
    v_mfma_f32_32x32x16_bf16 a[0:15], v[72:75], v[48:51], a[0:15]
    v_mfma_f32_32x32x16_bf16 a[16:31], v[76:79], v[48:51], a[16:31]
    v_mfma_f32_32x32x16_bf16 a[32:47], v[80:83], v[48:51], a[32:47]
    v_mfma_f32_32x32x16_bf16 a[48:63], v[84:87], v[48:51], a[48:63]
    ds_read_b128 v[72:75], v5 offset:10240
    ds_read_b128 v[76:79], v5 offset:38912
    ds_read_b128 v[80:83], v7 offset:10240
    ds_read_b128 v[84:87], v7 offset:38912
    s_waitcnt vmcnt(28) lgkmcnt(4)
    v_mfma_f32_32x32x16_bf16 a[0:15], v[88:91], v[52:55], a[0:15]
    v_mfma_f32_32x32x16_bf16 a[16:31], v[92:95], v[52:55], a[16:31]
    v_mfma_f32_32x32x16_bf16 a[32:47], v[96:99], v[52:55], a[32:47]
    v_mfma_f32_32x32x16_bf16 a[48:63], v[100:103], v[52:55], a[48:63]
    ds_read_b128 v[88:91], v5 offset:11264
    ds_read_b128 v[92:95], v5 offset:39936
    ds_read_b128 v[96:99], v7 offset:11264
    ds_read_b128 v[100:103], v7 offset:39936
    s_waitcnt vmcnt(27) lgkmcnt(4)
    v_mfma_f32_32x32x16_bf16 a[0:15], v[72:75], v[56:59], a[0:15]
    v_mfma_f32_32x32x16_bf16 a[16:31], v[76:79], v[56:59], a[16:31]
    v_mfma_f32_32x32x16_bf16 a[32:47], v[80:83], v[56:59], a[32:47]
    v_mfma_f32_32x32x16_bf16 a[48:63], v[84:87], v[56:59], a[48:63]
    ds_read_b128 v[72:75], v5 offset:12288
    ds_read_b128 v[76:79], v5 offset:40960
    ds_read_b128 v[80:83], v7 offset:12288
    ds_read_b128 v[84:87], v7 offset:40960
    s_waitcnt vmcnt(26) lgkmcnt(4)
    v_mfma_f32_32x32x16_bf16 a[0:15], v[88:91], v[60:63], a[0:15]
    v_mfma_f32_32x32x16_bf16 a[16:31], v[92:95], v[60:63], a[16:31]
    v_mfma_f32_32x32x16_bf16 a[32:47], v[96:99], v[60:63], a[32:47]
    v_mfma_f32_32x32x16_bf16 a[48:63], v[100:103], v[60:63], a[48:63]
    ds_read_b128 v[88:91], v5 offset:13312
    ds_read_b128 v[92:95], v5 offset:41984
    ds_read_b128 v[96:99], v7 offset:13312
    ds_read_b128 v[100:103], v7 offset:41984
    s_waitcnt vmcnt(25) lgkmcnt(4)
    v_mfma_f32_32x32x16_bf16 a[0:15], v[72:75], v[64:67], a[0:15]
    v_mfma_f32_32x32x16_bf16 a[16:31], v[76:79], v[64:67], a[16:31]
    v_mfma_f32_32x32x16_bf16 a[32:47], v[80:83], v[64:67], a[32:47]
    v_mfma_f32_32x32x16_bf16 a[48:63], v[84:87], v[64:67], a[48:63]
    s_waitcnt vmcnt(24) lgkmcnt(0)
    v_mfma_f32_32x32x16_bf16 a[0:15], v[88:91], v[68:71], a[0:15]
    v_mfma_f32_32x32x16_bf16 a[16:31], v[92:95], v[68:71], a[16:31]
    v_mfma_f32_32x32x16_bf16 a[32:47], v[96:99], v[68:71], a[32:47]
    v_mfma_f32_32x32x16_bf16 a[48:63], v[100:103], v[68:71], a[48:63]
    s_waitcnt vmcnt(22)
    s_barrier
    v_and_b32 v6, 31, v1
    s_lshl_b32 s39, s34, 5
    v_add_u32 v6, s39, v6
    v_mul_u32_u24 v6, 112, v6
    v_add_u32 v6, 114688, v6
    ds_read_b128 v[72:75], v6 offset:0
    ds_read_b128 v[76:79], v6 offset:16
    ds_read_b128 v[80:83], v6 offset:32
    ds_read_b128 v[84:87], v6 offset:48
    ds_read_b128 v[88:91], v6 offset:64
    ds_read_b128 v[92:95], v6 offset:80
    ds_read_b128 v[96:99], v6 offset:96
    s_lshl_b32 s40, s34, 14
    v_add_u32 v7, s40, v2
    s_cmp_eq_u32 s35, 0
    s_cbranch_scc1 KME_w0
    ds_write_b128 v7, a[0:3] offset:0
    ds_write_b128 v7, a[4:7] offset:1024
    ds_write_b128 v7, a[8:11] offset:2048
    ds_write_b128 v7, a[12:15] offset:3072
    ds_write_b128 v7, a[16:19] offset:4096
    ds_write_b128 v7, a[20:23] offset:5120
    ds_write_b128 v7, a[24:27] offset:6144
    ds_write_b128 v7, a[28:31] offset:7168
    s_branch KME_w1
KME_w0:
    ds_write_b128 v7, a[32:35] offset:8192
    ds_write_b128 v7, a[36:39] offset:9216
    ds_write_b128 v7, a[40:43] offset:10240
    ds_write_b128 v7, a[44:47] offset:11264
    ds_write_b128 v7, a[48:51] offset:12288
    ds_write_b128 v7, a[52:55] offset:13312
    ds_write_b128 v7, a[56:59] offset:14336
    ds_write_b128 v7, a[60:63] offset:15360
KME_w1:
    v_lshrrev_b32 v6, 5, v1
    v_lshlrev_b32 v6, 4, v6
    s_lshl_b32 s39, s35, 9
    s_add_u32 s39, s39, 129024
    v_add_u32 v6, s39, v6
    s_waitcnt lgkmcnt(0)
    s_barrier
    v_add_f32 v72, v72, v74
    v_add_f32 v73, v73, v75
    v_add_f32 v72, v72, v76
    v_add_f32 v73, v73, v77
    v_add_f32 v72, v72, v78
    v_add_f32 v73, v73, v79
    v_add_f32 v72, v72, v80
    v_add_f32 v73, v73, v81
    v_add_f32 v72, v72, v82
    v_add_f32 v73, v73, v83
    v_add_f32 v72, v72, v84
    v_add_f32 v73, v73, v85
    v_add_f32 v72, v72, v86
    v_add_f32 v73, v73, v87
    v_add_f32 v72, v72, v88
    v_add_f32 v73, v73, v89
    v_add_f32 v72, v72, v90
    v_add_f32 v73, v73, v91
    v_add_f32 v72, v72, v92
    v_add_f32 v73, v73, v93
    v_add_f32 v72, v72, v94
    v_add_f32 v73, v73, v95
    v_add_f32 v72, v72, v96
    v_add_f32 v73, v73, v97
    v_add_f32 v72, v72, v98
    v_add_f32 v73, v73, v99
    v_mul_f32 v72, 0x3b124925, v72
    v_mul_f32 v73, 0x3b124925, v73
    v_fma_f32 v73, -v72, v72, v73
    v_max_f32 v73, 0, v73
    v_cvt_pk_bf16_f32 v73, v73, v73
    v_lshlrev_b32 v73, 16, v73
    v_add_f32 v73, 0x3727c5ac, v73
    v_cvt_pk_bf16_f32 v73, v73, v73
    v_lshlrev_b32 v73, 16, v73
    v_sqrt_f32 v73, v73
    s_nop 0
    v_cvt_pk_bf16_f32 v73, v73, v73
    v_lshlrev_b32 v73, 16, v73
    v_rcp_f32 v14, v73
    v_cvt_pk_bf16_f32 v72, v72, v72
    v_lshlrev_b32 v72, 16, v72
    v_mul_f32 v15, v72, v14
    v_sub_f32 v15, 0, v15
    s_mul_i32 s37, s36, 114688
    s_mul_i32 s38, s25, 8192
    s_add_u32 s37, s37, s38
    s_add_u32 s37, s37, 13631488
    s_cmp_eq_u32 s35, 0
    s_cbranch_scc0 KME_f1
    ds_read_b128 v[16:19], v7 offset:0
    ds_read_b128 v[20:23], v7 offset:1024
    ds_read_b128 v[24:27], v7 offset:2048
    ds_read_b128 v[28:31], v7 offset:3072
    ds_read_b128 v[48:51], v6 offset:0
    ds_read_b128 v[64:67], v6 offset:128
    ds_read_b128 v[52:55], v6 offset:32
    ds_read_b128 v[68:71], v6 offset:160
    ds_read_b128 v[56:59], v6 offset:64
    ds_read_b128 v[72:75], v6 offset:192
    ds_read_b128 v[60:63], v6 offset:96
    ds_read_b128 v[76:79], v6 offset:224
    v_accvgpr_read_b32 v32, a0
    v_accvgpr_read_b32 v33, a1
    v_accvgpr_read_b32 v34, a2
    v_accvgpr_read_b32 v35, a3
    v_accvgpr_read_b32 v36, a4
    v_accvgpr_read_b32 v37, a5
    v_accvgpr_read_b32 v38, a6
    v_accvgpr_read_b32 v39, a7
    v_accvgpr_read_b32 v40, a8
    v_accvgpr_read_b32 v41, a9
    v_accvgpr_read_b32 v42, a10
    v_accvgpr_read_b32 v43, a11
    v_accvgpr_read_b32 v44, a12
    v_accvgpr_read_b32 v45, a13
    v_accvgpr_read_b32 v46, a14
    v_accvgpr_read_b32 v47, a15
    s_waitcnt lgkmcnt(0)
    v_add_f32 v32, v32, v16
    v_fma_f32 v64, v48, v15, v64
    v_fma_f32 v32, v32, v14, v64
    v_max_f32 v32, 0, v32
    v_add_f32 v33, v33, v17
    v_fma_f32 v65, v49, v15, v65
    v_fma_f32 v33, v33, v14, v65
    v_max_f32 v33, 0, v33
    v_add_f32 v34, v34, v18
    v_fma_f32 v66, v50, v15, v66
    v_fma_f32 v34, v34, v14, v66
    v_max_f32 v34, 0, v34
    v_add_f32 v35, v35, v19
    v_fma_f32 v67, v51, v15, v67
    v_fma_f32 v35, v35, v14, v67
    v_max_f32 v35, 0, v35
    v_add_f32 v36, v36, v20
    v_fma_f32 v68, v52, v15, v68
    v_fma_f32 v36, v36, v14, v68
    v_max_f32 v36, 0, v36
    v_add_f32 v37, v37, v21
    v_fma_f32 v69, v53, v15, v69
    v_fma_f32 v37, v37, v14, v69
    v_max_f32 v37, 0, v37
    v_add_f32 v38, v38, v22
    v_fma_f32 v70, v54, v15, v70
    v_fma_f32 v38, v38, v14, v70
    v_max_f32 v38, 0, v38
    v_add_f32 v39, v39, v23
    v_fma_f32 v71, v55, v15, v71
    v_fma_f32 v39, v39, v14, v71
    v_max_f32 v39, 0, v39
    v_add_f32 v40, v40, v24
    v_fma_f32 v72, v56, v15, v72
    v_fma_f32 v40, v40, v14, v72
    v_max_f32 v40, 0, v40
    v_add_f32 v41, v41, v25
    v_fma_f32 v73, v57, v15, v73
    v_fma_f32 v41, v41, v14, v73
    v_max_f32 v41, 0, v41
    v_add_f32 v42, v42, v26
    v_fma_f32 v74, v58, v15, v74
    v_fma_f32 v42, v42, v14, v74
    v_max_f32 v42, 0, v42
    v_add_f32 v43, v43, v27
    v_fma_f32 v75, v59, v15, v75
    v_fma_f32 v43, v43, v14, v75
    v_max_f32 v43, 0, v43
    v_add_f32 v44, v44, v28
    v_fma_f32 v76, v60, v15, v76
    v_fma_f32 v44, v44, v14, v76
    v_max_f32 v44, 0, v44
    v_add_f32 v45, v45, v29
    v_fma_f32 v77, v61, v15, v77
    v_fma_f32 v45, v45, v14, v77
    v_max_f32 v45, 0, v45
    v_add_f32 v46, v46, v30
    v_fma_f32 v78, v62, v15, v78
    v_fma_f32 v46, v46, v14, v78
    v_max_f32 v46, 0, v46
    v_add_f32 v47, v47, v31
    v_fma_f32 v79, v63, v15, v79
    v_fma_f32 v47, v47, v14, v79
    v_max_f32 v47, 0, v47
    v_cvt_pk_bf16_f32 v80, v32, v33
    v_cvt_pk_bf16_f32 v81, v34, v35
    v_cvt_pk_bf16_f32 v82, v36, v37
    v_cvt_pk_bf16_f32 v83, v38, v39
    v_cvt_pk_bf16_f32 v84, v40, v41
    v_cvt_pk_bf16_f32 v85, v42, v43
    v_cvt_pk_bf16_f32 v86, v44, v45
    v_cvt_pk_bf16_f32 v87, v46, v47
    s_add_u32 s38, s37, 0
    buffer_store_dwordx4 v[80:83], v2, s[8:11], s38 offen sc1
    buffer_store_dwordx4 v[84:87], v2, s[8:11], s38 offen offset:1024 sc1
    ds_read_b128 v[16:19], v7 offset:4096
    ds_read_b128 v[20:23], v7 offset:5120
    ds_read_b128 v[24:27], v7 offset:6144
    ds_read_b128 v[28:31], v7 offset:7168
    ds_read_b128 v[48:51], v6 offset:256
    ds_read_b128 v[64:67], v6 offset:384
    ds_read_b128 v[52:55], v6 offset:288
    ds_read_b128 v[68:71], v6 offset:416
    ds_read_b128 v[56:59], v6 offset:320
    ds_read_b128 v[72:75], v6 offset:448
    ds_read_b128 v[60:63], v6 offset:352
    ds_read_b128 v[76:79], v6 offset:480
    v_accvgpr_read_b32 v32, a16
    v_accvgpr_read_b32 v33, a17
    v_accvgpr_read_b32 v34, a18
    v_accvgpr_read_b32 v35, a19
    v_accvgpr_read_b32 v36, a20
    v_accvgpr_read_b32 v37, a21
    v_accvgpr_read_b32 v38, a22
    v_accvgpr_read_b32 v39, a23
    v_accvgpr_read_b32 v40, a24
    v_accvgpr_read_b32 v41, a25
    v_accvgpr_read_b32 v42, a26
    v_accvgpr_read_b32 v43, a27
    v_accvgpr_read_b32 v44, a28
    v_accvgpr_read_b32 v45, a29
    v_accvgpr_read_b32 v46, a30
    v_accvgpr_read_b32 v47, a31
    s_waitcnt lgkmcnt(0)
    v_add_f32 v32, v32, v16
    v_fma_f32 v64, v48, v15, v64
    v_fma_f32 v32, v32, v14, v64
    v_max_f32 v32, 0, v32
    v_add_f32 v33, v33, v17
    v_fma_f32 v65, v49, v15, v65
    v_fma_f32 v33, v33, v14, v65
    v_max_f32 v33, 0, v33
    v_add_f32 v34, v34, v18
    v_fma_f32 v66, v50, v15, v66
    v_fma_f32 v34, v34, v14, v66
    v_max_f32 v34, 0, v34
    v_add_f32 v35, v35, v19
    v_fma_f32 v67, v51, v15, v67
    v_fma_f32 v35, v35, v14, v67
    v_max_f32 v35, 0, v35
    v_add_f32 v36, v36, v20
    v_fma_f32 v68, v52, v15, v68
    v_fma_f32 v36, v36, v14, v68
    v_max_f32 v36, 0, v36
    v_add_f32 v37, v37, v21
    v_fma_f32 v69, v53, v15, v69
    v_fma_f32 v37, v37, v14, v69
    v_max_f32 v37, 0, v37
    v_add_f32 v38, v38, v22
    v_fma_f32 v70, v54, v15, v70
    v_fma_f32 v38, v38, v14, v70
    v_max_f32 v38, 0, v38
    v_add_f32 v39, v39, v23
    v_fma_f32 v71, v55, v15, v71
    v_fma_f32 v39, v39, v14, v71
    v_max_f32 v39, 0, v39
    v_add_f32 v40, v40, v24
    v_fma_f32 v72, v56, v15, v72
    v_fma_f32 v40, v40, v14, v72
    v_max_f32 v40, 0, v40
    v_add_f32 v41, v41, v25
    v_fma_f32 v73, v57, v15, v73
    v_fma_f32 v41, v41, v14, v73
    v_max_f32 v41, 0, v41
    v_add_f32 v42, v42, v26
    v_fma_f32 v74, v58, v15, v74
    v_fma_f32 v42, v42, v14, v74
    v_max_f32 v42, 0, v42
    v_add_f32 v43, v43, v27
    v_fma_f32 v75, v59, v15, v75
    v_fma_f32 v43, v43, v14, v75
    v_max_f32 v43, 0, v43
    v_add_f32 v44, v44, v28
    v_fma_f32 v76, v60, v15, v76
    v_fma_f32 v44, v44, v14, v76
    v_max_f32 v44, 0, v44
    v_add_f32 v45, v45, v29
    v_fma_f32 v77, v61, v15, v77
    v_fma_f32 v45, v45, v14, v77
    v_max_f32 v45, 0, v45
    v_add_f32 v46, v46, v30
    v_fma_f32 v78, v62, v15, v78
    v_fma_f32 v46, v46, v14, v78
    v_max_f32 v46, 0, v46
    v_add_f32 v47, v47, v31
    v_fma_f32 v79, v63, v15, v79
    v_fma_f32 v47, v47, v14, v79
    v_max_f32 v47, 0, v47
    v_cvt_pk_bf16_f32 v88, v32, v33
    v_cvt_pk_bf16_f32 v89, v34, v35
    v_cvt_pk_bf16_f32 v90, v36, v37
    v_cvt_pk_bf16_f32 v91, v38, v39
    v_cvt_pk_bf16_f32 v92, v40, v41
    v_cvt_pk_bf16_f32 v93, v42, v43
    v_cvt_pk_bf16_f32 v94, v44, v45
    v_cvt_pk_bf16_f32 v95, v46, v47
    s_add_u32 s38, s37, 2048
    buffer_store_dwordx4 v[88:91], v2, s[8:11], s38 offen sc1
    buffer_store_dwordx4 v[92:95], v2, s[8:11], s38 offen offset:1024 sc1
    s_branch KME_f2
KME_f1:
    ds_read_b128 v[16:19], v7 offset:8192
    ds_read_b128 v[20:23], v7 offset:9216
    ds_read_b128 v[24:27], v7 offset:10240
    ds_read_b128 v[28:31], v7 offset:11264
    ds_read_b128 v[48:51], v6 offset:0
    ds_read_b128 v[64:67], v6 offset:128
    ds_read_b128 v[52:55], v6 offset:32
    ds_read_b128 v[68:71], v6 offset:160
    ds_read_b128 v[56:59], v6 offset:64
    ds_read_b128 v[72:75], v6 offset:192
    ds_read_b128 v[60:63], v6 offset:96
    ds_read_b128 v[76:79], v6 offset:224
    v_accvgpr_read_b32 v32, a32
    v_accvgpr_read_b32 v33, a33
    v_accvgpr_read_b32 v34, a34
    v_accvgpr_read_b32 v35, a35
    v_accvgpr_read_b32 v36, a36
    v_accvgpr_read_b32 v37, a37
    v_accvgpr_read_b32 v38, a38
    v_accvgpr_read_b32 v39, a39
    v_accvgpr_read_b32 v40, a40
    v_accvgpr_read_b32 v41, a41
    v_accvgpr_read_b32 v42, a42
    v_accvgpr_read_b32 v43, a43
    v_accvgpr_read_b32 v44, a44
    v_accvgpr_read_b32 v45, a45
    v_accvgpr_read_b32 v46, a46
    v_accvgpr_read_b32 v47, a47
    s_waitcnt lgkmcnt(0)
    v_add_f32 v32, v32, v16
    v_fma_f32 v64, v48, v15, v64
    v_fma_f32 v32, v32, v14, v64
    v_max_f32 v32, 0, v32
    v_add_f32 v33, v33, v17
    v_fma_f32 v65, v49, v15, v65
    v_fma_f32 v33, v33, v14, v65
    v_max_f32 v33, 0, v33
    v_add_f32 v34, v34, v18
    v_fma_f32 v66, v50, v15, v66
    v_fma_f32 v34, v34, v14, v66
    v_max_f32 v34, 0, v34
    v_add_f32 v35, v35, v19
    v_fma_f32 v67, v51, v15, v67
    v_fma_f32 v35, v35, v14, v67
    v_max_f32 v35, 0, v35
    v_add_f32 v36, v36, v20
    v_fma_f32 v68, v52, v15, v68
    v_fma_f32 v36, v36, v14, v68
    v_max_f32 v36, 0, v36
    v_add_f32 v37, v37, v21
    v_fma_f32 v69, v53, v15, v69
    v_fma_f32 v37, v37, v14, v69
    v_max_f32 v37, 0, v37
    v_add_f32 v38, v38, v22
    v_fma_f32 v70, v54, v15, v70
    v_fma_f32 v38, v38, v14, v70
    v_max_f32 v38, 0, v38
    v_add_f32 v39, v39, v23
    v_fma_f32 v71, v55, v15, v71
    v_fma_f32 v39, v39, v14, v71
    v_max_f32 v39, 0, v39
    v_add_f32 v40, v40, v24
    v_fma_f32 v72, v56, v15, v72
    v_fma_f32 v40, v40, v14, v72
    v_max_f32 v40, 0, v40
    v_add_f32 v41, v41, v25
    v_fma_f32 v73, v57, v15, v73
    v_fma_f32 v41, v41, v14, v73
    v_max_f32 v41, 0, v41
    v_add_f32 v42, v42, v26
    v_fma_f32 v74, v58, v15, v74
    v_fma_f32 v42, v42, v14, v74
    v_max_f32 v42, 0, v42
    v_add_f32 v43, v43, v27
    v_fma_f32 v75, v59, v15, v75
    v_fma_f32 v43, v43, v14, v75
    v_max_f32 v43, 0, v43
    v_add_f32 v44, v44, v28
    v_fma_f32 v76, v60, v15, v76
    v_fma_f32 v44, v44, v14, v76
    v_max_f32 v44, 0, v44
    v_add_f32 v45, v45, v29
    v_fma_f32 v77, v61, v15, v77
    v_fma_f32 v45, v45, v14, v77
    v_max_f32 v45, 0, v45
    v_add_f32 v46, v46, v30
    v_fma_f32 v78, v62, v15, v78
    v_fma_f32 v46, v46, v14, v78
    v_max_f32 v46, 0, v46
    v_add_f32 v47, v47, v31
    v_fma_f32 v79, v63, v15, v79
    v_fma_f32 v47, v47, v14, v79
    v_max_f32 v47, 0, v47
    v_cvt_pk_bf16_f32 v80, v32, v33
    v_cvt_pk_bf16_f32 v81, v34, v35
    v_cvt_pk_bf16_f32 v82, v36, v37
    v_cvt_pk_bf16_f32 v83, v38, v39
    v_cvt_pk_bf16_f32 v84, v40, v41
    v_cvt_pk_bf16_f32 v85, v42, v43
    v_cvt_pk_bf16_f32 v86, v44, v45
    v_cvt_pk_bf16_f32 v87, v46, v47
    s_add_u32 s38, s37, 4096
    buffer_store_dwordx4 v[80:83], v2, s[8:11], s38 offen sc1
    buffer_store_dwordx4 v[84:87], v2, s[8:11], s38 offen offset:1024 sc1
    ds_read_b128 v[16:19], v7 offset:12288
    ds_read_b128 v[20:23], v7 offset:13312
    ds_read_b128 v[24:27], v7 offset:14336
    ds_read_b128 v[28:31], v7 offset:15360
    ds_read_b128 v[48:51], v6 offset:256
    ds_read_b128 v[64:67], v6 offset:384
    ds_read_b128 v[52:55], v6 offset:288
    ds_read_b128 v[68:71], v6 offset:416
    ds_read_b128 v[56:59], v6 offset:320
    ds_read_b128 v[72:75], v6 offset:448
    ds_read_b128 v[60:63], v6 offset:352
    ds_read_b128 v[76:79], v6 offset:480
    v_accvgpr_read_b32 v32, a48
    v_accvgpr_read_b32 v33, a49
    v_accvgpr_read_b32 v34, a50
    v_accvgpr_read_b32 v35, a51
    v_accvgpr_read_b32 v36, a52
    v_accvgpr_read_b32 v37, a53
    v_accvgpr_read_b32 v38, a54
    v_accvgpr_read_b32 v39, a55
    v_accvgpr_read_b32 v40, a56
    v_accvgpr_read_b32 v41, a57
    v_accvgpr_read_b32 v42, a58
    v_accvgpr_read_b32 v43, a59
    v_accvgpr_read_b32 v44, a60
    v_accvgpr_read_b32 v45, a61
    v_accvgpr_read_b32 v46, a62
    v_accvgpr_read_b32 v47, a63
    s_waitcnt lgkmcnt(0)
    v_add_f32 v32, v32, v16
    v_fma_f32 v64, v48, v15, v64
    v_fma_f32 v32, v32, v14, v64
    v_max_f32 v32, 0, v32
    v_add_f32 v33, v33, v17
    v_fma_f32 v65, v49, v15, v65
    v_fma_f32 v33, v33, v14, v65
    v_max_f32 v33, 0, v33
    v_add_f32 v34, v34, v18
    v_fma_f32 v66, v50, v15, v66
    v_fma_f32 v34, v34, v14, v66
    v_max_f32 v34, 0, v34
    v_add_f32 v35, v35, v19
    v_fma_f32 v67, v51, v15, v67
    v_fma_f32 v35, v35, v14, v67
    v_max_f32 v35, 0, v35
    v_add_f32 v36, v36, v20
    v_fma_f32 v68, v52, v15, v68
    v_fma_f32 v36, v36, v14, v68
    v_max_f32 v36, 0, v36
    v_add_f32 v37, v37, v21
    v_fma_f32 v69, v53, v15, v69
    v_fma_f32 v37, v37, v14, v69
    v_max_f32 v37, 0, v37
    v_add_f32 v38, v38, v22
    v_fma_f32 v70, v54, v15, v70
    v_fma_f32 v38, v38, v14, v70
    v_max_f32 v38, 0, v38
    v_add_f32 v39, v39, v23
    v_fma_f32 v71, v55, v15, v71
    v_fma_f32 v39, v39, v14, v71
    v_max_f32 v39, 0, v39
    v_add_f32 v40, v40, v24
    v_fma_f32 v72, v56, v15, v72
    v_fma_f32 v40, v40, v14, v72
    v_max_f32 v40, 0, v40
    v_add_f32 v41, v41, v25
    v_fma_f32 v73, v57, v15, v73
    v_fma_f32 v41, v41, v14, v73
    v_max_f32 v41, 0, v41
    v_add_f32 v42, v42, v26
    v_fma_f32 v74, v58, v15, v74
    v_fma_f32 v42, v42, v14, v74
    v_max_f32 v42, 0, v42
    v_add_f32 v43, v43, v27
    v_fma_f32 v75, v59, v15, v75
    v_fma_f32 v43, v43, v14, v75
    v_max_f32 v43, 0, v43
    v_add_f32 v44, v44, v28
    v_fma_f32 v76, v60, v15, v76
    v_fma_f32 v44, v44, v14, v76
    v_max_f32 v44, 0, v44
    v_add_f32 v45, v45, v29
    v_fma_f32 v77, v61, v15, v77
    v_fma_f32 v45, v45, v14, v77
    v_max_f32 v45, 0, v45
    v_add_f32 v46, v46, v30
    v_fma_f32 v78, v62, v15, v78
    v_fma_f32 v46, v46, v14, v78
    v_max_f32 v46, 0, v46
    v_add_f32 v47, v47, v31
    v_fma_f32 v79, v63, v15, v79
    v_fma_f32 v47, v47, v14, v79
    v_max_f32 v47, 0, v47
    v_cvt_pk_bf16_f32 v88, v32, v33
    v_cvt_pk_bf16_f32 v89, v34, v35
    v_cvt_pk_bf16_f32 v90, v36, v37
    v_cvt_pk_bf16_f32 v91, v38, v39
    v_cvt_pk_bf16_f32 v92, v40, v41
    v_cvt_pk_bf16_f32 v93, v42, v43
    v_cvt_pk_bf16_f32 v94, v44, v45
    v_cvt_pk_bf16_f32 v95, v46, v47
    s_add_u32 s38, s37, 6144
    buffer_store_dwordx4 v[88:91], v2, s[8:11], s38 offen sc1
    buffer_store_dwordx4 v[92:95], v2, s[8:11], s38 offen offset:1024 sc1
KME_f2:
    s_waitcnt vmcnt(0)
    s_barrier
    s_cmp_lg_u32 s26, 0
    s_cbranch_scc1 SIG12
    s_mov_b64 s[40:41], exec
    s_mov_b64 exec, 1
    v_mov_b32 v3, 0
    v_mov_b32 v4, 1
    s_lshl_b32 s42, s24, 9
    s_add_u32 s42, s42, 32530432
    buffer_atomic_add v4, v3, s[8:11], s42 offen
    s_mov_b64 exec, s[40:41]
SIG12:
    buffer_load_dwordx4 v[16:19], v2, s[8:11], s62 offen offset:3072
    buffer_load_dwordx4 v[20:23], v2, s[8:11], s63 offen offset:3072
    s_add_u32 s62, s62, 4096
    s_add_u32 s63, s63, 4096
    buffer_load_dwordx4 v[24:27], v2, s[8:11], s62 offen offset:0
    buffer_load_dwordx4 v[28:31], v2, s[8:11], s63 offen offset:0
    buffer_load_dwordx4 v[32:35], v2, s[8:11], s62 offen offset:1024
    buffer_load_dwordx4 v[36:39], v2, s[8:11], s63 offen offset:1024
    s_cmp_lg_u32 s26, 0
    s_cbranch_scc1 WAIT13_bar
    v_mov_b32 v3, 0
    s_mov_b32 s40, 0
    s_sub_i32 s41, s24, 0
    s_max_i32 s41, s41, 0
    s_lshl_b32 s41, s41, 9
    s_add_u32 s41, s41, 32530432
WAIT13_loop:
    buffer_load_dword v4, v3, s[8:11], s41 offen sc1
    s_waitcnt vmcnt(0)
    s_nop 0
    v_readfirstlane_b32 s44, v4
    s_add_u32 s40, s40, 1
    s_cmp_ge_u32 s40, 0x40000
    s_cbranch_scc1 WAIT13_bar
    s_cmp_ge_u32 s44, 14
    s_cbranch_scc1 WAIT13_bar
    s_sleep 2
    s_branch WAIT13_loop
WAIT13_bar:
    s_barrier
    s_mov_b32 s34, s58
    s_mov_b32 s35, s59
    buffer_load_dwordx4 v[40:43], v2, s[8:11], s56 offen offset:0
    buffer_load_dwordx4 v[44:47], v2, s[8:11], s57 offen offset:0
    buffer_load_dwordx4 v[48:51], v2, s[8:11], s56 offen offset:1024
    buffer_load_dwordx4 v[52:55], v2, s[8:11], s57 offen offset:1024
    buffer_load_dwordx4 v[56:59], v2, s[8:11], s56 offen offset:2048
    buffer_load_dwordx4 v[60:63], v2, s[8:11], s57 offen offset:2048
    buffer_load_dwordx4 v[64:67], v2, s[8:11], s56 offen offset:3072
    buffer_load_dwordx4 v[68:71], v2, s[8:11], s57 offen offset:3072
    s_add_u32 s56, s56, 4096
    s_add_u32 s57, s57, 4096
    buffer_load_dwordx4 v[72:75], v2, s[8:11], s56 offen offset:0
    buffer_load_dwordx4 v[76:79], v2, s[8:11], s57 offen offset:0
    buffer_load_dwordx4 v[80:83], v2, s[8:11], s56 offen offset:1024
    buffer_load_dwordx4 v[84:87], v2, s[8:11], s57 offen offset:1024
    buffer_load_dwordx4 v[88:91], v2, s[8:11], s56 offen offset:2048
    buffer_load_dwordx4 v[92:95], v2, s[8:11], s57 offen offset:2048
    buffer_load_dwordx4 v[96:99], v2, s[8:11], s56 offen offset:3072
    buffer_load_dwordx4 v[100:103], v2, s[8:11], s57 offen offset:3072
    v_accvgpr_write_b32 a0, 0
    v_accvgpr_write_b32 a1, 0
    v_accvgpr_write_b32 a2, 0
    v_accvgpr_write_b32 a3, 0
    v_accvgpr_write_b32 a4, 0
    v_accvgpr_write_b32 a5, 0
    v_accvgpr_write_b32 a6, 0
    v_accvgpr_write_b32 a7, 0
    v_accvgpr_write_b32 a8, 0
    v_accvgpr_write_b32 a9, 0
    v_accvgpr_write_b32 a10, 0
    v_accvgpr_write_b32 a11, 0
    v_accvgpr_write_b32 a12, 0
    v_accvgpr_write_b32 a13, 0
    v_accvgpr_write_b32 a14, 0
    v_accvgpr_write_b32 a15, 0
    v_accvgpr_write_b32 a16, 0
    v_accvgpr_write_b32 a17, 0
    v_accvgpr_write_b32 a18, 0
    v_accvgpr_write_b32 a19, 0
    v_accvgpr_write_b32 a20, 0
    v_accvgpr_write_b32 a21, 0
    v_accvgpr_write_b32 a22, 0
    v_accvgpr_write_b32 a23, 0
    v_accvgpr_write_b32 a24, 0
    v_accvgpr_write_b32 a25, 0
    v_accvgpr_write_b32 a26, 0
    v_accvgpr_write_b32 a27, 0
    v_accvgpr_write_b32 a28, 0
    v_accvgpr_write_b32 a29, 0
    v_accvgpr_write_b32 a30, 0
    v_accvgpr_write_b32 a31, 0
    v_accvgpr_write_b32 a32, 0
    v_accvgpr_write_b32 a33, 0
    v_accvgpr_write_b32 a34, 0
    v_accvgpr_write_b32 a35, 0
    v_accvgpr_write_b32 a36, 0
    v_accvgpr_write_b32 a37, 0
    v_accvgpr_write_b32 a38, 0
    v_accvgpr_write_b32 a39, 0
    v_accvgpr_write_b32 a40, 0
    v_accvgpr_write_b32 a41, 0
    v_accvgpr_write_b32 a42, 0
    v_accvgpr_write_b32 a43, 0
    v_accvgpr_write_b32 a44, 0
    v_accvgpr_write_b32 a45, 0
    v_accvgpr_write_b32 a46, 0
    v_accvgpr_write_b32 a47, 0
    v_accvgpr_write_b32 a48, 0
    v_accvgpr_write_b32 a49, 0
    v_accvgpr_write_b32 a50, 0
    v_accvgpr_write_b32 a51, 0
    v_accvgpr_write_b32 a52, 0
    v_accvgpr_write_b32 a53, 0
    v_accvgpr_write_b32 a54, 0
    v_accvgpr_write_b32 a55, 0
    v_accvgpr_write_b32 a56, 0
    v_accvgpr_write_b32 a57, 0
    v_accvgpr_write_b32 a58, 0
    v_accvgpr_write_b32 a59, 0
    v_accvgpr_write_b32 a60, 0
    v_accvgpr_write_b32 a61, 0
    v_accvgpr_write_b32 a62, 0
    v_accvgpr_write_b32 a63, 0
    s_waitcnt vmcnt(14)
    v_mfma_f32_32x32x16_bf16 a[0:15], v[104:107], v[40:43], a[0:15]
    v_mfma_f32_32x32x16_bf16 a[16:31], v[108:111], v[40:43], a[16:31]
    v_mfma_f32_32x32x16_bf16 a[32:47], v[104:107], v[44:47], a[32:47]
    v_mfma_f32_32x32x16_bf16 a[48:63], v[108:111], v[44:47], a[48:63]
    s_add_u32 s56, s56, 4096
    s_add_u32 s57, s57, 4096
    buffer_load_dwordx4 v[40:43], v2, s[8:11], s56 offen offset:0
    buffer_load_dwordx4 v[44:47], v2, s[8:11], s57 offen offset:0
    s_waitcnt vmcnt(14)
    v_mfma_f32_32x32x16_bf16 a[0:15], v[112:115], v[48:51], a[0:15]
    v_mfma_f32_32x32x16_bf16 a[16:31], v[116:119], v[48:51], a[16:31]
    v_mfma_f32_32x32x16_bf16 a[32:47], v[112:115], v[52:55], a[32:47]
    v_mfma_f32_32x32x16_bf16 a[48:63], v[116:119], v[52:55], a[48:63]
    buffer_load_dwordx4 v[48:51], v2, s[8:11], s56 offen offset:1024
    buffer_load_dwordx4 v[52:55], v2, s[8:11], s57 offen offset:1024
    s_waitcnt vmcnt(14)
    v_mfma_f32_32x32x16_bf16 a[0:15], v[120:123], v[56:59], a[0:15]
    v_mfma_f32_32x32x16_bf16 a[16:31], v[124:127], v[56:59], a[16:31]
    v_mfma_f32_32x32x16_bf16 a[32:47], v[120:123], v[60:63], a[32:47]
    v_mfma_f32_32x32x16_bf16 a[48:63], v[124:127], v[60:63], a[48:63]
    buffer_load_dwordx4 v[56:59], v2, s[8:11], s56 offen offset:2048
    buffer_load_dwordx4 v[60:63], v2, s[8:11], s57 offen offset:2048
    s_waitcnt vmcnt(14)
    v_mfma_f32_32x32x16_bf16 a[0:15], v[128:131], v[64:67], a[0:15]
    v_mfma_f32_32x32x16_bf16 a[16:31], v[132:135], v[64:67], a[16:31]
    v_mfma_f32_32x32x16_bf16 a[32:47], v[128:131], v[68:71], a[32:47]
    v_mfma_f32_32x32x16_bf16 a[48:63], v[132:135], v[68:71], a[48:63]
    buffer_load_dwordx4 v[64:67], v2, s[8:11], s56 offen offset:3072
    buffer_load_dwordx4 v[68:71], v2, s[8:11], s57 offen offset:3072
    s_waitcnt vmcnt(14)
    v_mfma_f32_32x32x16_bf16 a[0:15], v[136:139], v[72:75], a[0:15]
    v_mfma_f32_32x32x16_bf16 a[16:31], v[140:143], v[72:75], a[16:31]
    v_mfma_f32_32x32x16_bf16 a[32:47], v[136:139], v[76:79], a[32:47]
    v_mfma_f32_32x32x16_bf16 a[48:63], v[140:143], v[76:79], a[48:63]
    s_add_u32 s56, s56, 4096
    s_add_u32 s57, s57, 4096
    buffer_load_dwordx4 v[72:75], v2, s[8:11], s56 offen offset:0
    buffer_load_dwordx4 v[76:79], v2, s[8:11], s57 offen offset:0
    s_waitcnt vmcnt(14)
    v_mfma_f32_32x32x16_bf16 a[0:15], v[144:147], v[80:83], a[0:15]
    v_mfma_f32_32x32x16_bf16 a[16:31], v[148:151], v[80:83], a[16:31]
    v_mfma_f32_32x32x16_bf16 a[32:47], v[144:147], v[84:87], a[32:47]
    v_mfma_f32_32x32x16_bf16 a[48:63], v[148:151], v[84:87], a[48:63]
    buffer_load_dwordx4 v[80:83], v2, s[8:11], s56 offen offset:1024
    buffer_load_dwordx4 v[84:87], v2, s[8:11], s57 offen offset:1024
    s_waitcnt vmcnt(14)
    v_mfma_f32_32x32x16_bf16 a[0:15], v[152:155], v[88:91], a[0:15]
    v_mfma_f32_32x32x16_bf16 a[16:31], v[156:159], v[88:91], a[16:31]
    v_mfma_f32_32x32x16_bf16 a[32:47], v[152:155], v[92:95], a[32:47]
    v_mfma_f32_32x32x16_bf16 a[48:63], v[156:159], v[92:95], a[48:63]
    s_waitcnt vmcnt(12)
    v_mfma_f32_32x32x16_bf16 a[0:15], v[160:163], v[96:99], a[0:15]
    v_mfma_f32_32x32x16_bf16 a[16:31], v[164:167], v[96:99], a[16:31]
    v_mfma_f32_32x32x16_bf16 a[32:47], v[160:163], v[100:103], a[32:47]
    v_mfma_f32_32x32x16_bf16 a[48:63], v[164:167], v[100:103], a[48:63]
    s_waitcnt vmcnt(10)
    v_mfma_f32_32x32x16_bf16 a[0:15], v[168:171], v[40:43], a[0:15]
    v_mfma_f32_32x32x16_bf16 a[16:31], v[172:175], v[40:43], a[16:31]
    v_mfma_f32_32x32x16_bf16 a[32:47], v[168:171], v[44:47], a[32:47]
    v_mfma_f32_32x32x16_bf16 a[48:63], v[172:175], v[44:47], a[48:63]
    s_waitcnt vmcnt(8)
    v_mfma_f32_32x32x16_bf16 a[0:15], v[176:179], v[48:51], a[0:15]
    v_mfma_f32_32x32x16_bf16 a[16:31], v[180:183], v[48:51], a[16:31]
    v_mfma_f32_32x32x16_bf16 a[32:47], v[176:179], v[52:55], a[32:47]
    v_mfma_f32_32x32x16_bf16 a[48:63], v[180:183], v[52:55], a[48:63]
    s_waitcnt vmcnt(6)
    v_mfma_f32_32x32x16_bf16 a[0:15], v[184:187], v[56:59], a[0:15]
    v_mfma_f32_32x32x16_bf16 a[16:31], v[188:191], v[56:59], a[16:31]
    v_mfma_f32_32x32x16_bf16 a[32:47], v[184:187], v[60:63], a[32:47]
    v_mfma_f32_32x32x16_bf16 a[48:63], v[188:191], v[60:63], a[48:63]
    s_waitcnt vmcnt(4)
    v_mfma_f32_32x32x16_bf16 a[0:15], v[16:19], v[64:67], a[0:15]
    v_mfma_f32_32x32x16_bf16 a[16:31], v[20:23], v[64:67], a[16:31]
    v_mfma_f32_32x32x16_bf16 a[32:47], v[16:19], v[68:71], a[32:47]
    v_mfma_f32_32x32x16_bf16 a[48:63], v[20:23], v[68:71], a[48:63]
    s_waitcnt vmcnt(2)
    v_mfma_f32_32x32x16_bf16 a[0:15], v[24:27], v[72:75], a[0:15]
    v_mfma_f32_32x32x16_bf16 a[16:31], v[28:31], v[72:75], a[16:31]
    v_mfma_f32_32x32x16_bf16 a[32:47], v[24:27], v[76:79], a[32:47]
    v_mfma_f32_32x32x16_bf16 a[48:63], v[28:31], v[76:79], a[48:63]
    s_waitcnt vmcnt(0)
    v_mfma_f32_32x32x16_bf16 a[0:15], v[32:35], v[80:83], a[0:15]
    v_mfma_f32_32x32x16_bf16 a[16:31], v[36:39], v[80:83], a[16:31]
    v_mfma_f32_32x32x16_bf16 a[32:47], v[32:35], v[84:87], a[32:47]
    v_mfma_f32_32x32x16_bf16 a[48:63], v[36:39], v[84:87], a[48:63]
    s_bfe_u32 s36, s26, 0x10001
    s_lshr_b32 s37, s26, 2
    s_and_b32 s38, s26, 1
    s_lshl_b32 s39, s35, 1
    s_add_u32 s39, s39, s36
    s_lshl_b32 s40, s34, 1
    s_add_u32 s40, s40, s37
    v_lshrrev_b32 v4, 5, v1
    v_and_b32 v5, 31, v1
    v_lshlrev_b32 v6, 4, v4
    s_lshl_b32 s41, s39, 7
    s_lshl_b32 s42, s38, 6
    s_add_u32 s41, s41, s42
    s_add_u32 s41, s41, 8960
    buffer_load_dwordx4 v[16:19], v6, s[8:11], s41 offen
    buffer_load_dwordx4 v[20:23], v6, s[8:11], s41 offen offset:32
    s_mul_i32 s41, s40, 28672
    s_lshl_b32 s42, s39, 11
    s_add_u32 s41, s41, s42
    s_lshl_b32 s42, s38, 10
    s_add_u32 s41, s41, s42
    s_add_u32 s41, s41, 10485760
    buffer_load_dwordx4 v[24:27], v2, s[8:11], s41 offen
    s_lshl_b32 s41, s40, 5
    v_add_u32 v7, s41, v5
    s_movk_i32 s41, 896
    v_mul_lo_u32 v8, v7, s41
    v_lshl_add_u32 v8, v4, 3, v8
    s_lshl_b32 s44, s39, 6
    s_lshl_b32 s42, s38, 5
    s_add_u32 s44, s44, s42
    s_lshl_b32 s41, s26, 11
    v_add_u32 v9, s41, v2
    v_add_u32 v10, 0x10000, v9
    s_nop 7
    s_nop 3
    ds_write_b128 v9, a[0:3] offset:0
    ds_write_b128 v9, a[4:7] offset:1024
    ds_write_b128 v9, a[8:11] offset:16384
    ds_write_b128 v9, a[12:15] offset:17408
    ds_write_b128 v9, a[16:19] offset:32768
    ds_write_b128 v9, a[20:23] offset:33792
    ds_write_b128 v9, a[24:27] offset:49152
    ds_write_b128 v9, a[28:31] offset:50176
    ds_write_b128 v10, a[32:35] offset:0
    ds_write_b128 v10, a[36:39] offset:1024
    ds_write_b128 v10, a[40:43] offset:16384
    ds_write_b128 v10, a[44:47] offset:17408
    ds_write_b128 v10, a[48:51] offset:32768
    ds_write_b128 v10, a[52:55] offset:33792
    ds_write_b128 v10, a[56:59] offset:49152
    ds_write_b128 v10, a[60:63] offset:50176
    s_waitcnt lgkmcnt(0)
    s_barrier
    s_lshl_b32 s41, s26, 14
    v_add_u32 v9, s41, v2
    ds_read_b128 v[40:43], v9 offset:0
    ds_read_b128 v[44:47], v9 offset:1024
    ds_read_b128 v[48:51], v9 offset:2048
    ds_read_b128 v[52:55], v9 offset:3072
    ds_read_b128 v[56:59], v9 offset:4096
    ds_read_b128 v[60:63], v9 offset:5120
    ds_read_b128 v[64:67], v9 offset:6144
    ds_read_b128 v[68:71], v9 offset:7168
    ds_read_b128 v[72:75], v9 offset:8192
    ds_read_b128 v[76:79], v9 offset:9216
    ds_read_b128 v[80:83], v9 offset:10240
    ds_read_b128 v[84:87], v9 offset:11264
    ds_read_b128 v[88:91], v9 offset:12288
    ds_read_b128 v[92:95], v9 offset:13312
    ds_read_b128 v[96:99], v9 offset:14336
    ds_read_b128 v[100:103], v9 offset:15360
    s_waitcnt lgkmcnt(0)
    v_add_f32 v28, v40, v48
    v_add_f32 v29, v41, v49
    v_add_f32 v30, v42, v50
    v_add_f32 v31, v43, v51
    v_add_f32 v32, v44, v52
    v_add_f32 v33, v45, v53
    v_add_f32 v34, v46, v54
    v_add_f32 v35, v47, v55
    v_add_f32 v28, v28, v56
    v_add_f32 v29, v29, v57
    v_add_f32 v30, v30, v58
    v_add_f32 v31, v31, v59
    v_add_f32 v32, v32, v60
    v_add_f32 v33, v33, v61
    v_add_f32 v34, v34, v62
    v_add_f32 v35, v35, v63
    v_add_f32 v28, v28, v64
    v_add_f32 v29, v29, v65
    v_add_f32 v30, v30, v66
    v_add_f32 v31, v31, v67
    v_add_f32 v32, v32, v68
    v_add_f32 v33, v33, v69
    v_add_f32 v34, v34, v70
    v_add_f32 v35, v35, v71
    v_add_f32 v28, v28, v72
    v_add_f32 v29, v29, v73
    v_add_f32 v30, v30, v74
    v_add_f32 v31, v31, v75
    v_add_f32 v32, v32, v76
    v_add_f32 v33, v33, v77
    v_add_f32 v34, v34, v78
    v_add_f32 v35, v35, v79
    v_add_f32 v28, v28, v80
    v_add_f32 v29, v29, v81
    v_add_f32 v30, v30, v82
    v_add_f32 v31, v31, v83
    v_add_f32 v32, v32, v84
    v_add_f32 v33, v33, v85
    v_add_f32 v34, v34, v86
    v_add_f32 v35, v35, v87
    v_add_f32 v28, v28, v88
    v_add_f32 v29, v29, v89
    v_add_f32 v30, v30, v90
    v_add_f32 v31, v31, v91
    v_add_f32 v32, v32, v92
    v_add_f32 v33, v33, v93
    v_add_f32 v34, v34, v94
    v_add_f32 v35, v35, v95
    v_add_f32 v28, v28, v96
    v_add_f32 v29, v29, v97
    v_add_f32 v30, v30, v98
    v_add_f32 v31, v31, v99
    v_add_f32 v32, v32, v100
    v_add_f32 v33, v33, v101
    v_add_f32 v34, v34, v102
    v_add_f32 v35, v35, v103
    s_waitcnt vmcnt(0)
    v_cvt_pk_bf16_f32 v10, v28, v29
    v_lshlrev_b32 v28, 16, v10
    v_and_b32 v29, 0xffff0000, v10
    v_mul_f32 v28, v28, v16
    v_mul_f32 v29, v29, v17
    v_cvt_pk_bf16_f32 v10, v28, v29
    v_lshlrev_b32 v28, 16, v10
    v_and_b32 v29, 0xffff0000, v10
    v_lshlrev_b32 v11, 16, v24
    v_and_b32 v12, 0xffff0000, v24
    v_add_f32 v28, v28, v11
    v_add_f32 v29, v29, v12
    v_cvt_pk_bf16_f32 v36, v28, v29
    v_cvt_pk_bf16_f32 v10, v30, v31
    v_lshlrev_b32 v30, 16, v10
    v_and_b32 v31, 0xffff0000, v10
    v_mul_f32 v30, v30, v18
    v_mul_f32 v31, v31, v19
    v_cvt_pk_bf16_f32 v10, v30, v31
    v_lshlrev_b32 v30, 16, v10
    v_and_b32 v31, 0xffff0000, v10
    v_lshlrev_b32 v11, 16, v25
    v_and_b32 v12, 0xffff0000, v25
    v_add_f32 v30, v30, v11
    v_add_f32 v31, v31, v12
    v_cvt_pk_bf16_f32 v37, v30, v31
    v_cvt_pk_bf16_f32 v10, v32, v33
    v_lshlrev_b32 v32, 16, v10
    v_and_b32 v33, 0xffff0000, v10
    v_mul_f32 v32, v32, v20
    v_mul_f32 v33, v33, v21
    v_cvt_pk_bf16_f32 v10, v32, v33
    v_lshlrev_b32 v32, 16, v10
    v_and_b32 v33, 0xffff0000, v10
    v_lshlrev_b32 v11, 16, v26
    v_and_b32 v12, 0xffff0000, v26
    v_add_f32 v32, v32, v11
    v_add_f32 v33, v33, v12
    v_cvt_pk_bf16_f32 v38, v32, v33
    v_cvt_pk_bf16_f32 v10, v34, v35
    v_lshlrev_b32 v34, 16, v10
    v_and_b32 v35, 0xffff0000, v10
    v_mul_f32 v34, v34, v22
    v_mul_f32 v35, v35, v23
    v_cvt_pk_bf16_f32 v10, v34, v35
    v_lshlrev_b32 v34, 16, v10
    v_and_b32 v35, 0xffff0000, v10
    v_lshlrev_b32 v11, 16, v27
    v_and_b32 v12, 0xffff0000, v27
    v_add_f32 v34, v34, v11
    v_add_f32 v35, v35, v12
    v_cvt_pk_bf16_f32 v39, v34, v35
    buffer_store_dwordx2 v[36:37], v8, s[16:19], s44 offen
    buffer_store_dwordx2 v[38:39], v8, s[16:19], s44 offen offset:16
KM_fl:
KM_exit:
    s_endpgm
.section .rodata,"a"
.p2align 6
.amdhsa_kernel adaLN_cond__sliding_block__dense_activation_relu__prompt_kernel
  .amdhsa_next_free_vgpr 256
  .amdhsa_next_free_sgpr 102
  .amdhsa_accum_offset 192
  .amdhsa_group_segment_fixed_size 0
  .amdhsa_kernarg_size 88
  .amdhsa_user_sgpr_count 2
  .amdhsa_user_sgpr_kernarg_segment_ptr 1
  .amdhsa_system_sgpr_workgroup_id_x 1
.end_amdhsa_kernel
```
